```python
import torch

def _softmax(x, axis=-1):
    return torch.softmax(x, dim=axis)
def _gelu(x):
    return torch.nn.functional.gelu(x, approximate="tanh")
def _silu(x):
    return torch.nn.functional.silu(x)
def _sigmoid(x):
    return torch.sigmoid(x)
def _layernorm(x, axis=-1, eps=1e-5):
    m = x.mean(dim=axis, keepdim=True)
    v = x.var(dim=axis, keepdim=True, unbiased=False)
    return (x - m) / torch.sqrt(v + eps)
def _scatter_add(tgt, idx, src, axis=0):
    return tgt.clone().index_add_(axis, idx, src)
def _segment_sum(src, seg, n):
    out = torch.zeros((n,) + src.shape[1:], dtype=src.dtype)
    return out.index_add_(0, seg, src)
def _pad(x, pw):
    flat = tuple(v for pair in reversed(pw) for v in pair)
    return torch.nn.functional.pad(x, flat)

kernel_name = 'concat_heads__gqa_block_cached__gqa_block_cached__near_ridge'

def setup_inputs():

    _w = (lambda a: (lambda t: t.to(torch.bfloat16) if t.is_floating_point() else t)(torch.as_tensor(a)))
    def _A_setup():
        B, Sq, D = 16, 32, 576
        Hq, Hkv, Sk, Dh = 32, 16, 32, 128
        assert Hq % Hkv == 0, (Hq, Hkv)
        return {
            "x": _w((lambda *s: torch.randn(*s, dtype=torch.bfloat16) * 0.8)(B, Sq, D)),
            "k_cache": _w((lambda *s: torch.randn(*s, dtype=torch.bfloat16) * 0.8)(B, Hkv, Sk, Dh)),
            "v_cache": _w((lambda *s: torch.randn(*s, dtype=torch.bfloat16) * 0.05)(B, Hkv, Sk, Dh)),
            "wq": _w((lambda *s: torch.randn(*s, dtype=torch.bfloat16) * 0.8)(D, Hq * Dh) * (D ** -0.5)),
            "wo": _w((lambda *s: torch.randn(*s, dtype=torch.bfloat16) * 0.05)(Hq * Dh, D) * ((Hq * Dh) ** -0.5)),
        }
    _A_in = _A_setup()

    def _B_setup():
        B, Sq, D = 16, 32, 576
        Hq, Hkv, Sk, Dh = 32, 16, 32, 128
        assert Hq % Hkv == 0, (Hq, Hkv)
        return {
            "x": _w((lambda *s: torch.randn(*s, dtype=torch.bfloat16) * 0.8)(B, Sq, D)),
            "k_cache": _w((lambda *s: torch.randn(*s, dtype=torch.bfloat16) * 0.8)(B, Hkv, Sk, Dh)),
            "v_cache": _w((lambda *s: torch.randn(*s, dtype=torch.bfloat16) * 0.05)(B, Hkv, Sk, Dh)),
            "wq": _w((lambda *s: torch.randn(*s, dtype=torch.bfloat16) * 0.8)(D, Hq * Dh) * (D ** -0.5)),
            "wo": _w((lambda *s: torch.randn(*s, dtype=torch.bfloat16) * 0.05)(Hq * Dh, D) * ((Hq * Dh) ** -0.5)),
        }
    _B_in = _B_setup()

    return {
        "A_x": _A_in["x"],
        "A_k_cache": _A_in["k_cache"],
        "A_v_cache": _A_in["v_cache"],
        "A_wq": _A_in["wq"],
        "A_wo": _A_in["wo"],
        "B_x": _B_in["x"],
        "B_k_cache": _B_in["k_cache"],
        "B_v_cache": _B_in["v_cache"],
        "B_wq": _B_in["wq"],
        "B_wo": _B_in["wo"],
    }

def reference(A_x, A_k_cache, A_v_cache, A_wq, A_wo, B_x, B_k_cache, B_v_cache, B_wq, B_wo):
    def _A_ref(x, k_cache, v_cache, wq, wo):
        B, Sq, D = x.shape
        Hq, Dh = 32, 128
        Hkv = k_cache.shape[1]
        rep = Hq // Hkv
        q = (lambda x, *d: x.permute(*d))((x @ wq).reshape(B, Sq, Hq, Dh), 0, 2, 1, 3)
        k = (lambda x, n, axis: torch.repeat_interleave(x, n, dim=axis))(k_cache, rep, axis=1)
        v = (lambda x, n, axis: torch.repeat_interleave(x, n, dim=axis))(v_cache, rep, axis=1)
        scores = torch.einsum("bhqd,bhkd->bhqk", q, k) * (Dh ** -0.5)
        p = _softmax(scores, axis=-1)
        o = torch.einsum("bhqk,bhkd->bhqd", p, v)
        return (lambda x, *d: x.permute(*d))(o, 0, 2, 1, 3).reshape(B, Sq, Hq * Dh) @ wo

    def _B_ref(x, k_cache, v_cache, wq, wo):
        B, Sq, D = x.shape
        Hq, Dh = 32, 128
        Hkv = k_cache.shape[1]
        rep = Hq // Hkv
        q = (lambda x, *d: x.permute(*d))((x @ wq).reshape(B, Sq, Hq, Dh), 0, 2, 1, 3)
        k = (lambda x, n, axis: torch.repeat_interleave(x, n, dim=axis))(k_cache, rep, axis=1)
        v = (lambda x, n, axis: torch.repeat_interleave(x, n, dim=axis))(v_cache, rep, axis=1)
        scores = torch.einsum("bhqd,bhkd->bhqk", q, k) * (Dh ** -0.5)
        p = _softmax(scores, axis=-1)
        o = torch.einsum("bhqk,bhkd->bhqd", p, v)
        return (lambda x, *d: x.permute(*d))(o, 0, 2, 1, 3).reshape(B, Sq, Hq * Dh) @ wo

    a = _A_ref(A_x, A_k_cache, A_v_cache, A_wq, A_wo)
    b = _B_ref(B_x, B_k_cache, B_v_cache, B_wq, B_wo)
    return torch.concatenate([a, b], axis=-1)
```

```asm
; @launch grid=(256,1,1) block=(256,1,1) lds=163840
.amdgcn_target "amdgcn-amd-amdhsa--gfx950"
.text
.globl concat_heads__gqa_block_cached__gqa_block_cached__near_ridge_kernel
.p2align 8
.type concat_heads__gqa_block_cached__gqa_block_cached__near_ridge_kernel,@function
concat_heads__gqa_block_cached__gqa_block_cached__near_ridge_kernel:
    s_cmp_ge_u32 s2, 256
    s_cbranch_scc1 L_end
    s_load_dwordx16 s[4:19], s[0:1], 0
    s_load_dwordx8 s[20:27], s[0:1], 64
    s_load_dwordx2 s[28:29], s[0:1], 96
    s_getpc_b64 s[64:65]
    s_mov_b32 s66, L_end-concat_heads__gqa_block_cached__gqa_block_cached__near_ridge_kernel
    s_mov_b32 s67, 0x20000
    v_lshlrev_b32 v1, 7, v0
    buffer_load_dword v1, v1, s[64:67], 0 offen
    v_lshrrev_b32 v4, 6, v0
    v_and_b32 v0, 63, v0
    v_readfirstlane_b32 s68, v4
    s_and_b32 s78, s2, 7
    s_lshr_b32 s79, s2, 3
    s_lshr_b32 s69, s78, 2
    s_and_b32 s70, s78, 3
    s_lshr_b32 s71, s79, 3
    s_and_b32 s72, s79, 7
    s_lshl_b32 s3, s78, 2
    s_add_u32 s3, s3, s71
    s_lshl_b32 s73, s70, 3
    s_add_u32 s73, s73, s72
    s_lshl_b32 s74, s71, 2
    s_add_u32 s74, s74, s68
    s_lshl_b32 s75, s68, 12
    s_and_b32 s82, s72, 3
    s_lshr_b32 s83, s72, 2
    s_mul_i32 s91, s71, 4
    s_mul_i32 s78, s72, 1
    s_add_u32 s91, s91, s78
    s_mul_i32 s78, s91, 7282
    s_lshr_b32 s78, s78, 16
    s_mul_i32 s78, s78, 9
    s_sub_u32 s91, s91, s78
    v_lshrrev_b32 v50, 3, v0
    v_and_b32 v51, 7, v0
    v_lshrrev_b32 v52, 4, v0
    s_mul_i32 s78, s74, 36864
    v_mul_u32_u24 v53, 1152, v50
    v_add_u32 v53, s78, v53
    v_xor_b32 v54, v51, v52
    v_xor_b32 v55, 4, v54
    v_lshl_add_u32 v4, v54, 4, v53
    v_lshl_add_u32 v5, v55, 4, v53
    v_add_u32 v6, 18432, v4
    v_add_u32 v5, 9216, v5
    v_add_u32 v7, 18432, v5
    v_and_b32 v54, 15, v0
    v_lshlrev_b32 v55, 2, v52
    v_xor_b32 v54, v54, v55
    v_lshlrev_b32 v54, 4, v54
    v_lshl_add_u32 v55, v52, 13, v54
    s_lshl_b32 s78, s68, 17
    s_lshl_b32 s79, s73, 8
    s_add_u32 s78, s78, s79
    v_add_u32 v8, s78, v55
    v_add_u32 v9, 32768, v8
    v_add_u32 v10, 65536, v8
    v_add_u32 v11, 98304, v8
    s_waitcnt lgkmcnt(0)
    s_cmp_eq_u32 s69, 1
    s_cselect_b32 s36, s20, s10
    s_cselect_b32 s37, s21, s11
    s_mov_b32 s38, 0x480000
    s_mov_b32 s39, 0x20000
    s_cselect_b32 s32, s14, s4
    s_cselect_b32 s33, s15, s5
    s_mov_b32 s34, 0x90000
    s_mov_b32 s35, 0x20000
    s_lshl_b32 s76, s91, 19
    s_lshl_b32 s77, s91, 7
    s_add_u32 m0, s75, 0
    s_nop 0
    buffer_load_dwordx4 v8, s[36:39], s76 offen  lds
    s_add_u32 m0, s75, 49152
    s_nop 0
    buffer_load_dwordx4 v4, s[32:35], s77 offen  lds
    s_add_u32 m0, s75, 1024
    s_nop 0
    buffer_load_dwordx4 v9, s[36:39], s76 offen  lds
    s_add_u32 m0, s75, 50176
    s_nop 0
    buffer_load_dwordx4 v5, s[32:35], s77 offen  lds
    s_add_u32 m0, s75, 2048
    s_nop 0
    buffer_load_dwordx4 v10, s[36:39], s76 offen  lds
    s_add_u32 m0, s75, 51200
    s_nop 0
    buffer_load_dwordx4 v6, s[32:35], s77 offen  lds
    s_cmp_eq_u32 s69, 1
    s_cselect_b32 s40, s16, s6
    s_cselect_b32 s41, s17, s7
    s_mov_b32 s42, 0x200000
    s_mov_b32 s43, 0x20000
    s_cselect_b32 s44, s18, s8
    s_cselect_b32 s45, s19, s9
    s_mov_b32 s46, 0x200000
    s_mov_b32 s47, 0x20000
    s_cselect_b32 s48, s22, s12
    s_cselect_b32 s49, s23, s13
    s_mov_b32 s50, 0x480000
    s_mov_b32 s51, 0x20000
    s_mov_b32 s56, s24
    s_mov_b32 s57, s25
    s_mov_b32 s58, 0x120000
    s_mov_b32 s59, 0x20000
    s_mov_b32 s60, s26
    s_mov_b32 s61, s27
    s_mov_b32 s62, 0x100
    s_mov_b32 s63, 0x20000
    s_mov_b32 s52, s28
    s_mov_b32 s53, s29
    s_mov_b32 s54, 0x2000000
    s_mov_b32 s55, 0x20000
    s_mov_b64 s[30:31], s[28:29]
    s_mov_b32 s64, 0
    s_mov_b32 s65, 0
    s_mov_b32 s66, 0
    s_or_b32 s78, s2, s68
    s_cmp_eq_u32 s78, 0
    s_cbranch_scc0 L_ann_1
    s_load_dwordx2 s[64:65], s[30:31], 32768
    s_load_dword s66, s[30:31], 262144
L_ann_1:
    s_lshl_b32 s78, s74, 4
    s_lshr_b32 s79, s73, 1
    s_add_u32 s78, s78, s79
    s_lshl_b32 s78, s78, 13
    v_lshl_add_u32 v54, v52, 8, v54
    v_add_u32 v24, s78, v54
    v_and_b32 v54, 15, v0
    v_xor_b32 v54, v54, v52
    v_lshlrev_b32 v54, 4, v54
    v_lshl_add_u32 v54, v52, 8, v54
    v_add_u32 v20, s78, v54
    v_xor_b32 v21, 64, v20
    v_xor_b32 v22, 128, v20
    v_xor_b32 v23, 192, v20
    s_lshl_b32 s85, s68, 14
    s_add_u32 s85, s85, 98304
    s_mov_b32 s84, 4096
    s_mov_b32 s96, 8192
    s_lshl_b32 s78, s3, 12
    s_lshl_b32 s79, s68, 10
    s_add_u32 s78, s78, s79
    s_add_u32 s78, s78, 262144
    s_lshl_b32 s79, s72, 7
    s_add_u32 s79, s79, s78
    v_mov_b32 v27, s79
    s_lshl_b32 s79, s83, 9
    s_add_u32 s89, s79, s78
    s_lshl_b32 s78, s69, 2
    s_add_u32 s78, s78, s71
    s_lshl_b32 s78, s78, 2
    s_add_u32 s78, s78, s82
    s_lshl_b32 s81, s70, 1
    s_add_u32 s81, s81, s83
    s_lshl_b32 s79, s78, 8
    s_add_u32 s79, s79, 65536
    s_lshl_b32 s80, s81, 5
    s_add_u32 s80, s80, s79
    v_and_b32 v56, 7, v0
    v_lshl_add_u32 v3, v56, 2, s80
    s_lshl_b32 s80, s68, 6
    s_add_u32 s79, s79, s80
    s_lshl_b32 s80, s81, 2
    s_add_u32 s79, s79, s80
    v_lshl_add_u32 v48, v0, 5, s79
    s_lshl_b32 s78, s78, 6
    s_lshl_b32 s79, s68, 4
    s_add_u32 s79, s79, s78
    s_add_u32 s79, s79, s81
    s_mul_i32 s79, s79, 4608
    s_add_u32 s79, s79, 9437184
    v_lshl_add_u32 v45, v0, 4, s79
    s_lshl_b32 s79, s81, 3
    s_add_u32 s79, s79, s78
    s_mul_i32 s79, s79, 4608
    s_add_u32 s79, s79, 9437184
    s_lshl_b32 s80, s68, 10
    s_add_u32 s79, s79, s80
    v_lshl_add_u32 v46, v0, 4, s79
    s_lshl_b32 s78, s71, 3
    s_add_u32 s78, s78, s81
    s_mul_i32 s78, s78, 36864
    s_mul_i32 s79, s69, 1152
    s_add_u32 s78, s78, s79
    s_mul_i32 s79, s82, 288
    s_add_u32 s78, s78, s79
    s_lshl_b32 s79, s68, 6
    s_add_u32 s78, s78, s79
    v_and_b32 v56, 15, v0
    v_mul_u32_u24 v56, 2304, v56
    v_lshrrev_b32 v57, 4, v0
    v_lshl_add_u32 v56, v57, 3, v56
    v_add_u32 v47, s78, v56
    v_and_b32 v50, 31, v0
    v_lshrrev_b32 v51, 5, v0
    v_bfe_u32 v52, v0, 1, 3
    v_xor_b32 v52, v52, v51
    s_add_u32 s78, s75, 49152
    v_lshl_add_u32 v53, v50, 7, s78
    v_xor_b32 v54, 0, v52
    v_lshl_add_u32 v12, v54, 4, v53
    v_xor_b32 v54, 2, v52
    v_lshl_add_u32 v13, v54, 4, v53
    v_xor_b32 v54, 4, v52
    v_lshl_add_u32 v14, v54, 4, v53
    v_xor_b32 v54, 6, v52
    v_lshl_add_u32 v15, v54, 4, v53
    v_and_b32 v54, 15, v0
    v_xor_b32 v54, v54, v51
    v_lshlrev_b32 v54, 4, v54
    v_lshl_add_u32 v54, v50, 8, v54
    v_add_u32 v25, s85, v54
    s_lshl_b32 s78, s69, 4
    s_add_u32 s78, s78, s74
    s_lshl_b32 s78, s78, 5
    s_add_u32 s78, s78, s73
    s_lshl_b32 s78, s78, 11
    s_add_u32 s78, s78, 1048576
    v_lshl_add_u32 v26, v0, 4, s78
    v_bfe_u32 v50, v0, 2, 2
    v_lshl_add_u32 v52, v51, 3, v50
    v_lshlrev_b32 v52, 8, v52
    v_bfe_u32 v53, v0, 4, 1
    v_lshl_add_u32 v52, v53, 5, v52
    v_and_b32 v53, 1, v0
    v_lshl_add_u32 v52, v53, 4, v52
    v_bfe_u32 v53, v0, 1, 1
    v_lshl_add_u32 v52, v53, 3, v52
    s_add_u32 s78, s85, 8192
    v_lshlrev_b32 v51, 10, v51
    v_sub_u32 v51, s78, v51
    v_xor_b32 v53, 0, v50
    v_lshl_add_u32 v16, v53, 6, v52
    v_add_u32 v28, v16, v51
    v_xor_b32 v53, 1, v50
    v_lshl_add_u32 v17, v53, 6, v52
    v_add_u32 v29, v17, v51
    v_xor_b32 v53, 2, v50
    v_lshl_add_u32 v18, v53, 6, v52
    v_add_u32 v30, v18, v51
    v_xor_b32 v53, 3, v50
    v_lshl_add_u32 v19, v53, 6, v52
    v_add_u32 v31, v19, v51
    s_lshl_b32 s78, s70, 1
    s_add_u32 s78, s78, s83
    s_lshl_b32 s78, s78, 4
    s_add_u32 s78, s78, s68
    s_mul_i32 s78, s78, 36864
    s_mul_i32 s79, s82, 288
    s_add_u32 s78, s78, s79
    v_add_u32 v50, 0, v0
    v_mul_u32_u24 v51, 3641, v50
    v_lshrrev_b32 v51, 16, v51
    v_mul_u32_u24 v52, 18, v51
    v_sub_u32 v50, v50, v52
    v_bfe_u32 v52, v51, 2, 2
    v_lshrrev_b32 v53, 4, v51
    v_and_b32 v51, 3, v51
    v_lshl_add_u32 v51, v53, 2, v51
    v_and_b32 v53, 1, v52
    v_lshl_add_u32 v51, v53, 4, v51
    v_lshrrev_b32 v53, 1, v52
    v_lshl_add_u32 v51, v53, 3, v51
    v_mul_u32_u24 v51, 1152, v51
    v_lshl_add_u32 v51, v50, 4, v51
    v_add_u32 v32, s78, v51
    v_add_u32 v50, 64, v0
    v_mul_u32_u24 v51, 3641, v50
    v_lshrrev_b32 v51, 16, v51
    v_mul_u32_u24 v52, 18, v51
    v_sub_u32 v50, v50, v52
    v_bfe_u32 v52, v51, 2, 2
    v_lshrrev_b32 v53, 4, v51
    v_and_b32 v51, 3, v51
    v_lshl_add_u32 v51, v53, 2, v51
    v_and_b32 v53, 1, v52
    v_lshl_add_u32 v51, v53, 4, v51
    v_lshrrev_b32 v53, 1, v52
    v_lshl_add_u32 v51, v53, 3, v51
    v_mul_u32_u24 v51, 1152, v51
    v_lshl_add_u32 v51, v50, 4, v51
    v_add_u32 v33, s78, v51
    v_add_u32 v50, 128, v0
    v_mul_u32_u24 v51, 3641, v50
    v_lshrrev_b32 v51, 16, v51
    v_mul_u32_u24 v52, 18, v51
    v_sub_u32 v50, v50, v52
    v_bfe_u32 v52, v51, 2, 2
    v_lshrrev_b32 v53, 4, v51
    v_and_b32 v51, 3, v51
    v_lshl_add_u32 v51, v53, 2, v51
    v_and_b32 v53, 1, v52
    v_lshl_add_u32 v51, v53, 4, v51
    v_lshrrev_b32 v53, 1, v52
    v_lshl_add_u32 v51, v53, 3, v51
    v_mul_u32_u24 v51, 1152, v51
    v_lshl_add_u32 v51, v50, 4, v51
    v_add_u32 v34, s78, v51
    v_add_u32 v50, 192, v0
    v_mul_u32_u24 v51, 3641, v50
    v_lshrrev_b32 v51, 16, v51
    v_mul_u32_u24 v52, 18, v51
    v_sub_u32 v50, v50, v52
    v_bfe_u32 v52, v51, 2, 2
    v_lshrrev_b32 v53, 4, v51
    v_and_b32 v51, 3, v51
    v_lshl_add_u32 v51, v53, 2, v51
    v_and_b32 v53, 1, v52
    v_lshl_add_u32 v51, v53, 4, v51
    v_lshrrev_b32 v53, 1, v52
    v_lshl_add_u32 v51, v53, 3, v51
    v_mul_u32_u24 v51, 1152, v51
    v_lshl_add_u32 v51, v50, 4, v51
    v_add_u32 v35, s78, v51
    v_add_u32 v50, 256, v0
    v_mul_u32_u24 v51, 3641, v50
    v_lshrrev_b32 v51, 16, v51
    v_mul_u32_u24 v52, 18, v51
    v_sub_u32 v50, v50, v52
    v_bfe_u32 v52, v51, 2, 2
    v_lshrrev_b32 v53, 4, v51
    v_and_b32 v51, 3, v51
    v_lshl_add_u32 v51, v53, 2, v51
    v_and_b32 v53, 1, v52
    v_lshl_add_u32 v51, v53, 4, v51
    v_lshrrev_b32 v53, 1, v52
    v_lshl_add_u32 v51, v53, 3, v51
    v_mul_u32_u24 v51, 1152, v51
    v_lshl_add_u32 v51, v50, 4, v51
    v_add_u32 v36, s78, v51
    v_add_u32 v50, 320, v0
    v_mul_u32_u24 v51, 3641, v50
    v_lshrrev_b32 v51, 16, v51
    v_mul_u32_u24 v52, 18, v51
    v_sub_u32 v50, v50, v52
    v_bfe_u32 v52, v51, 2, 2
    v_lshrrev_b32 v53, 4, v51
    v_and_b32 v51, 3, v51
    v_lshl_add_u32 v51, v53, 2, v51
    v_and_b32 v53, 1, v52
    v_lshl_add_u32 v51, v53, 4, v51
    v_lshrrev_b32 v53, 1, v52
    v_lshl_add_u32 v51, v53, 3, v51
    v_mul_u32_u24 v51, 1152, v51
    v_lshl_add_u32 v51, v50, 4, v51
    v_add_u32 v37, s78, v51
    v_add_u32 v50, 384, v0
    v_mul_u32_u24 v51, 3641, v50
    v_lshrrev_b32 v51, 16, v51
    v_mul_u32_u24 v52, 18, v51
    v_sub_u32 v50, v50, v52
    v_bfe_u32 v52, v51, 2, 2
    v_lshrrev_b32 v53, 4, v51
    v_and_b32 v51, 3, v51
    v_lshl_add_u32 v51, v53, 2, v51
    v_and_b32 v53, 1, v52
    v_lshl_add_u32 v51, v53, 4, v51
    v_lshrrev_b32 v53, 1, v52
    v_lshl_add_u32 v51, v53, 3, v51
    v_mul_u32_u24 v51, 1152, v51
    v_lshl_add_u32 v51, v50, 4, v51
    v_add_u32 v38, s78, v51
    v_add_u32 v50, 448, v0
    v_mul_u32_u24 v51, 3641, v50
    v_lshrrev_b32 v51, 16, v51
    v_mul_u32_u24 v52, 18, v51
    v_sub_u32 v50, v50, v52
    v_bfe_u32 v52, v51, 2, 2
    v_lshrrev_b32 v53, 4, v51
    v_and_b32 v51, 3, v51
    v_lshl_add_u32 v51, v53, 2, v51
    v_and_b32 v53, 1, v52
    v_lshl_add_u32 v51, v53, 4, v51
    v_lshrrev_b32 v53, 1, v52
    v_lshl_add_u32 v51, v53, 3, v51
    v_mul_u32_u24 v51, 1152, v51
    v_lshl_add_u32 v51, v50, 4, v51
    v_add_u32 v39, s78, v51
    v_add_u32 v50, 512, v0
    v_mul_u32_u24 v51, 3641, v50
    v_lshrrev_b32 v51, 16, v51
    v_mul_u32_u24 v52, 18, v51
    v_sub_u32 v50, v50, v52
    v_bfe_u32 v52, v51, 2, 2
    v_lshrrev_b32 v53, 4, v51
    v_and_b32 v51, 3, v51
    v_lshl_add_u32 v51, v53, 2, v51
    v_and_b32 v53, 1, v52
    v_lshl_add_u32 v51, v53, 4, v51
    v_lshrrev_b32 v53, 1, v52
    v_lshl_add_u32 v51, v53, 3, v51
    v_mul_u32_u24 v51, 1152, v51
    v_lshl_add_u32 v51, v50, 4, v51
    v_add_u32 v40, s78, v51
    s_mul_i32 s88, s68, 9216
    s_add_u32 s97, s75, 147456
    v_lshrrev_b32 v50, 2, v0
    v_mul_u32_u24 v50, 288, v50
    v_and_b32 v51, 3, v0
    v_lshl_add_u32 v41, v51, 3, v50
    v_add_u32 v42, 55296, v41
    v_add_u32 v43, 110592, v41
    s_lshl_b32 s78, s69, 4
    s_add_u32 s78, s78, s74
    s_lshl_b32 s78, s78, 3
    s_lshl_b32 s79, s70, 1
    s_add_u32 s78, s78, s79
    s_add_u32 s78, s78, s83
    s_lshl_b32 s78, s78, 13
    s_add_u32 s78, s78, 1048576
    v_lshl_add_u32 v44, v0, 4, s78
    s_xor_b32 s78, s82, 0
    s_mul_i32 s92, s78, 147456
    s_xor_b32 s78, s82, 1
    s_mul_i32 s93, s78, 147456
    s_xor_b32 s78, s82, 2
    s_mul_i32 s94, s78, 147456
    s_xor_b32 s78, s82, 3
    s_mul_i32 s95, s78, 147456
    s_lshr_b32 s79, s2, 3
    s_lshl_b32 s78, s70, 5
    s_add_u32 s78, s78, s79
    s_lshl_b32 s78, s78, 2
    s_add_u32 s78, s78, s68
    s_mul_i32 s78, s78, 9216
    v_lshl_add_u32 v49, v0, 7, s78
    s_or_b32 s78, s2, s68
    s_cmp_eq_u32 s78, 0
    s_cbranch_scc0 L_ep_2
    s_waitcnt lgkmcnt(0)
    s_or_b32 s64, s64, 1
    s_mul_i32 s78, s64, 0x4c957f2d
    s_mul_hi_u32 s79, s64, 0x4c957f2d
    s_mul_i32 s80, s64, 0x5851f42d
    s_add_u32 s79, s79, s80
    s_mul_i32 s80, s65, 0x4c957f2d
    s_add_u32 s79, s79, s80
    s_or_b32 s80, s79, 1
    s_xor_b32 s81, s80, 0xa5a5a5a4
    s_cmp_eq_u32 s80, s66
    s_cselect_b32 s80, s81, s80
    v_mov_b32 v50, s78
    v_mov_b32 v51, s79
    v_mov_b32 v52, s80
    v_mov_b32 v53, 0
    v_mov_b32 v54, 32768
    s_mov_b64 exec, 1
    buffer_store_dword v52, v53, s[60:63], 0 offen sc1
    buffer_store_dwordx2 v[50:51], v54, s[52:55], 0 offen sc1
    s_mov_b64 exec, -1
L_ep_2:
    s_add_u32 m0, s75, 3072
    s_nop 0
    buffer_load_dwordx4 v11, s[36:39], s76 offen  lds
    s_add_u32 m0, s75, 52224
    s_nop 0
    buffer_load_dwordx4 v7, s[32:35], s77 offen  lds
    s_add_u32 s91, s91, 1
    s_cmp_eq_u32 s91, 9
    s_cselect_b32 s91, 0, s91
    s_lshl_b32 s76, s91, 19
    s_lshl_b32 s77, s91, 7
    s_add_u32 m0, s75, 16384
    s_nop 0
    buffer_load_dwordx4 v8, s[36:39], s76 offen  lds
    s_add_u32 m0, s75, 65536
    s_nop 0
    buffer_load_dwordx4 v4, s[32:35], s77 offen  lds
    s_add_u32 m0, s75, 17408
    s_nop 0
    buffer_load_dwordx4 v9, s[36:39], s76 offen  lds
    s_add_u32 m0, s75, 66560
    s_nop 0
    buffer_load_dwordx4 v5, s[32:35], s77 offen  lds
    s_add_u32 m0, s75, 18432
    s_nop 0
    buffer_load_dwordx4 v10, s[36:39], s76 offen  lds
    s_add_u32 m0, s75, 67584
    s_nop 0
    buffer_load_dwordx4 v6, s[32:35], s77 offen  lds
    s_add_u32 m0, s75, 19456
    s_nop 0
    buffer_load_dwordx4 v11, s[36:39], s76 offen  lds
    s_add_u32 m0, s75, 68608
    s_nop 0
    buffer_load_dwordx4 v7, s[32:35], s77 offen  lds
    s_add_u32 s91, s91, 1
    s_cmp_eq_u32 s91, 9
    s_cselect_b32 s91, 0, s91
    s_lshl_b32 s76, s91, 19
    s_lshl_b32 s77, s91, 7
    s_add_u32 m0, s75, 32768
    s_nop 0
    buffer_load_dwordx4 v8, s[36:39], s76 offen  lds
    s_add_u32 m0, s75, 81920
    s_nop 0
    buffer_load_dwordx4 v4, s[32:35], s77 offen  lds
    s_add_u32 m0, s75, 33792
    s_nop 0
    buffer_load_dwordx4 v9, s[36:39], s76 offen  lds
    s_add_u32 m0, s75, 82944
    s_nop 0
    buffer_load_dwordx4 v5, s[32:35], s77 offen  lds
    s_add_u32 m0, s75, 34816
    s_nop 0
    buffer_load_dwordx4 v10, s[36:39], s76 offen  lds
    s_add_u32 m0, s75, 83968
    s_nop 0
    buffer_load_dwordx4 v6, s[32:35], s77 offen  lds
    s_add_u32 m0, s75, 35840
    s_nop 0
    buffer_load_dwordx4 v11, s[36:39], s76 offen  lds
    s_add_u32 m0, s75, 84992
    s_nop 0
    buffer_load_dwordx4 v7, s[32:35], s77 offen  lds
    s_waitcnt vmcnt(16)
    s_barrier
    ds_read_b128 v[60:63], v12 offset:0
    ds_read_b64_tr_b16 v[68:69], v16 offset:0
    ds_read_b64_tr_b16 v[70:71], v16 offset:1024
    ds_read_b64_tr_b16 v[72:73], v17 offset:0
    ds_read_b64_tr_b16 v[74:75], v17 offset:1024
    ds_read_b64_tr_b16 v[76:77], v18 offset:0
    ds_read_b64_tr_b16 v[78:79], v18 offset:1024
    ds_read_b64_tr_b16 v[80:81], v19 offset:0
    ds_read_b64_tr_b16 v[82:83], v19 offset:1024
    s_waitcnt lgkmcnt(6)
    v_mfma_f32_32x32x16_bf16 v[100:115], v[68:71], v[60:63], 0
    ds_read_b128 v[64:67], v13 offset:0
    ds_read_b64_tr_b16 v[84:85], v16 offset:4096
    ds_read_b64_tr_b16 v[86:87], v16 offset:5120
    s_waitcnt lgkmcnt(7)
    v_mfma_f32_32x32x16_bf16 v[116:131], v[72:75], v[60:63], 0
    ds_read_b64_tr_b16 v[88:89], v17 offset:4096
    ds_read_b64_tr_b16 v[90:91], v17 offset:5120
    s_waitcnt lgkmcnt(7)
    v_mfma_f32_32x32x16_bf16 v[132:147], v[76:79], v[60:63], 0
    ds_read_b64_tr_b16 v[92:93], v18 offset:4096
    ds_read_b64_tr_b16 v[94:95], v18 offset:5120
    s_waitcnt lgkmcnt(7)
    v_mfma_f32_32x32x16_bf16 v[148:163], v[80:83], v[60:63], 0
    ds_read_b64_tr_b16 v[96:97], v19 offset:4096
    ds_read_b64_tr_b16 v[98:99], v19 offset:5120
    s_waitcnt lgkmcnt(6)
    v_mfma_f32_32x32x16_bf16 v[100:115], v[84:87], v[64:67], v[100:115]
    ds_read_b128 v[60:63], v14 offset:0
    ds_read_b64_tr_b16 v[68:69], v16 offset:8192
    ds_read_b64_tr_b16 v[70:71], v16 offset:9216
    s_waitcnt lgkmcnt(7)
    v_mfma_f32_32x32x16_bf16 v[116:131], v[88:91], v[64:67], v[116:131]
    ds_read_b64_tr_b16 v[72:73], v17 offset:8192
    ds_read_b64_tr_b16 v[74:75], v17 offset:9216
    s_waitcnt lgkmcnt(7)
    v_mfma_f32_32x32x16_bf16 v[132:147], v[92:95], v[64:67], v[132:147]
    ds_read_b64_tr_b16 v[76:77], v18 offset:8192
    ds_read_b64_tr_b16 v[78:79], v18 offset:9216
    s_waitcnt lgkmcnt(7)
    v_mfma_f32_32x32x16_bf16 v[148:163], v[96:99], v[64:67], v[148:163]
    ds_read_b64_tr_b16 v[80:81], v19 offset:8192
    ds_read_b64_tr_b16 v[82:83], v19 offset:9216
    s_waitcnt lgkmcnt(6)
    v_mfma_f32_32x32x16_bf16 v[100:115], v[68:71], v[60:63], v[100:115]
    ds_read_b128 v[64:67], v15 offset:0
    ds_read_b64_tr_b16 v[84:85], v16 offset:12288
    ds_read_b64_tr_b16 v[86:87], v16 offset:13312
    s_waitcnt lgkmcnt(7)
    v_mfma_f32_32x32x16_bf16 v[116:131], v[72:75], v[60:63], v[116:131]
    ds_read_b64_tr_b16 v[88:89], v17 offset:12288
    ds_read_b64_tr_b16 v[90:91], v17 offset:13312
    s_waitcnt lgkmcnt(7)
    v_mfma_f32_32x32x16_bf16 v[132:147], v[76:79], v[60:63], v[132:147]
    ds_read_b64_tr_b16 v[92:93], v18 offset:12288
    ds_read_b64_tr_b16 v[94:95], v18 offset:13312
    s_waitcnt lgkmcnt(7)
    v_mfma_f32_32x32x16_bf16 v[148:163], v[80:83], v[60:63], v[148:163]
    ds_read_b64_tr_b16 v[96:97], v19 offset:12288
    ds_read_b64_tr_b16 v[98:99], v19 offset:13312
    s_waitcnt lgkmcnt(6)
    v_mfma_f32_32x32x16_bf16 v[100:115], v[84:87], v[64:67], v[100:115]
    s_waitcnt lgkmcnt(4)
    v_mfma_f32_32x32x16_bf16 v[116:131], v[88:91], v[64:67], v[116:131]
    s_waitcnt lgkmcnt(0)
    s_waitcnt vmcnt(8)
    s_barrier
    ds_read_b128 v[60:63], v12 offset:16384
    ds_read_b64_tr_b16 v[68:69], v16 offset:16384
    ds_read_b64_tr_b16 v[70:71], v16 offset:17408
    s_add_u32 s91, s91, 1
    s_cmp_eq_u32 s91, 9
    s_cselect_b32 s91, 0, s91
    s_lshl_b32 s76, s91, 19
    s_lshl_b32 s77, s91, 7
    s_add_u32 m0, s75, 0
    s_nop 0
    buffer_load_dwordx4 v8, s[36:39], s76 offen  lds
    v_mfma_f32_32x32x16_bf16 v[132:147], v[92:95], v[64:67], v[132:147]
    ds_read_b64_tr_b16 v[72:73], v17 offset:16384
    ds_read_b64_tr_b16 v[74:75], v17 offset:17408
    ds_read_b64_tr_b16 v[76:77], v18 offset:16384
    s_add_u32 m0, s75, 49152
    s_nop 0
    buffer_load_dwordx4 v4, s[32:35], s77 offen  lds
    v_mfma_f32_32x32x16_bf16 v[148:163], v[96:99], v[64:67], v[148:163]
    ds_read_b64_tr_b16 v[78:79], v18 offset:17408
    ds_read_b64_tr_b16 v[80:81], v19 offset:16384
    ds_read_b64_tr_b16 v[82:83], v19 offset:17408
    s_waitcnt lgkmcnt(6)
    v_mfma_f32_32x32x16_bf16 v[100:115], v[68:71], v[60:63], v[100:115]
    ds_read_b128 v[64:67], v13 offset:16384
    ds_read_b64_tr_b16 v[84:85], v16 offset:20480
    ds_read_b64_tr_b16 v[86:87], v16 offset:21504
    s_waitcnt lgkmcnt(7)
    v_mfma_f32_32x32x16_bf16 v[116:131], v[72:75], v[60:63], v[116:131]
    ds_read_b64_tr_b16 v[88:89], v17 offset:20480
    ds_read_b64_tr_b16 v[90:91], v17 offset:21504
    s_add_u32 m0, s75, 1024
    s_nop 0
    buffer_load_dwordx4 v9, s[36:39], s76 offen  lds
    s_waitcnt lgkmcnt(7)
    v_mfma_f32_32x32x16_bf16 v[132:147], v[76:79], v[60:63], v[132:147]
    ds_read_b64_tr_b16 v[92:93], v18 offset:20480
    ds_read_b64_tr_b16 v[94:95], v18 offset:21504
    s_add_u32 m0, s75, 50176
    s_nop 0
    buffer_load_dwordx4 v5, s[32:35], s77 offen  lds
    s_waitcnt lgkmcnt(7)
    v_mfma_f32_32x32x16_bf16 v[148:163], v[80:83], v[60:63], v[148:163]
    ds_read_b64_tr_b16 v[96:97], v19 offset:20480
    ds_read_b64_tr_b16 v[98:99], v19 offset:21504
    s_waitcnt lgkmcnt(6)
    v_mfma_f32_32x32x16_bf16 v[100:115], v[84:87], v[64:67], v[100:115]
    ds_read_b128 v[60:63], v14 offset:16384
    ds_read_b64_tr_b16 v[68:69], v16 offset:24576
    ds_read_b64_tr_b16 v[70:71], v16 offset:25600
    s_waitcnt lgkmcnt(7)
    v_mfma_f32_32x32x16_bf16 v[116:131], v[88:91], v[64:67], v[116:131]
    ds_read_b64_tr_b16 v[72:73], v17 offset:24576
    ds_read_b64_tr_b16 v[74:75], v17 offset:25600
    s_add_u32 m0, s75, 2048
    s_nop 0
    buffer_load_dwordx4 v10, s[36:39], s76 offen  lds
    s_waitcnt lgkmcnt(7)
    v_mfma_f32_32x32x16_bf16 v[132:147], v[92:95], v[64:67], v[132:147]
    ds_read_b64_tr_b16 v[76:77], v18 offset:24576
    ds_read_b64_tr_b16 v[78:79], v18 offset:25600
    s_add_u32 m0, s75, 51200
    s_nop 0
    buffer_load_dwordx4 v6, s[32:35], s77 offen  lds
    s_waitcnt lgkmcnt(7)
    v_mfma_f32_32x32x16_bf16 v[148:163], v[96:99], v[64:67], v[148:163]
    ds_read_b64_tr_b16 v[80:81], v19 offset:24576
    ds_read_b64_tr_b16 v[82:83], v19 offset:25600
    s_waitcnt lgkmcnt(6)
    v_mfma_f32_32x32x16_bf16 v[100:115], v[68:71], v[60:63], v[100:115]
    ds_read_b128 v[64:67], v15 offset:16384
    ds_read_b64_tr_b16 v[84:85], v16 offset:28672
    ds_read_b64_tr_b16 v[86:87], v16 offset:29696
    s_waitcnt lgkmcnt(7)
    v_mfma_f32_32x32x16_bf16 v[116:131], v[72:75], v[60:63], v[116:131]
    ds_read_b64_tr_b16 v[88:89], v17 offset:28672
    ds_read_b64_tr_b16 v[90:91], v17 offset:29696
    s_add_u32 m0, s75, 3072
    s_nop 0
    buffer_load_dwordx4 v11, s[36:39], s76 offen  lds
    s_waitcnt lgkmcnt(7)
    v_mfma_f32_32x32x16_bf16 v[132:147], v[76:79], v[60:63], v[132:147]
    ds_read_b64_tr_b16 v[92:93], v18 offset:28672
    ds_read_b64_tr_b16 v[94:95], v18 offset:29696
    s_add_u32 m0, s75, 52224
    s_nop 0
    buffer_load_dwordx4 v7, s[32:35], s77 offen  lds
    s_waitcnt lgkmcnt(7)
    v_mfma_f32_32x32x16_bf16 v[148:163], v[80:83], v[60:63], v[148:163]
    ds_read_b64_tr_b16 v[96:97], v19 offset:28672
    ds_read_b64_tr_b16 v[98:99], v19 offset:29696
    s_waitcnt lgkmcnt(6)
    v_mfma_f32_32x32x16_bf16 v[100:115], v[84:87], v[64:67], v[100:115]
    s_waitcnt lgkmcnt(4)
    v_mfma_f32_32x32x16_bf16 v[116:131], v[88:91], v[64:67], v[116:131]
    s_waitcnt lgkmcnt(0)
    s_waitcnt vmcnt(8)
    s_barrier
    ds_read_b128 v[60:63], v12 offset:32768
    ds_read_b64_tr_b16 v[68:69], v16 offset:32768
    ds_read_b64_tr_b16 v[70:71], v16 offset:33792
    s_add_u32 s91, s91, 1
    s_cmp_eq_u32 s91, 9
    s_cselect_b32 s91, 0, s91
    s_lshl_b32 s76, s91, 19
    s_lshl_b32 s77, s91, 7
    s_add_u32 m0, s75, 16384
    s_nop 0
    buffer_load_dwordx4 v8, s[36:39], s76 offen  lds
    s_add_u32 m0, s75, 65536
    s_nop 0
    buffer_load_dwordx4 v4, s[32:35], s77 offen  lds
    v_mfma_f32_32x32x16_bf16 v[132:147], v[92:95], v[64:67], v[132:147]
    ds_read_b64_tr_b16 v[72:73], v17 offset:32768
    ds_read_b64_tr_b16 v[74:75], v17 offset:33792
    ds_read_b64_tr_b16 v[76:77], v18 offset:32768
    s_add_u32 m0, s75, 17408
    s_nop 0
    buffer_load_dwordx4 v9, s[36:39], s76 offen  lds
    v_mfma_f32_32x32x16_bf16 v[148:163], v[96:99], v[64:67], v[148:163]
    ds_read_b64_tr_b16 v[78:79], v18 offset:33792
    ds_read_b64_tr_b16 v[80:81], v19 offset:32768
    ds_read_b64_tr_b16 v[82:83], v19 offset:33792
    s_add_u32 m0, s75, 66560
    s_nop 0
    buffer_load_dwordx4 v5, s[32:35], s77 offen  lds
    s_waitcnt lgkmcnt(6)
    v_mfma_f32_32x32x16_bf16 v[100:115], v[68:71], v[60:63], v[100:115]
    ds_read_b128 v[64:67], v13 offset:32768
    ds_read_b64_tr_b16 v[84:85], v16 offset:36864
    ds_read_b64_tr_b16 v[86:87], v16 offset:37888
    s_add_u32 m0, s75, 18432
    s_nop 0
    buffer_load_dwordx4 v10, s[36:39], s76 offen  lds
    s_waitcnt lgkmcnt(7)
    v_mfma_f32_32x32x16_bf16 v[116:131], v[72:75], v[60:63], v[116:131]
    ds_read_b64_tr_b16 v[88:89], v17 offset:36864
    ds_read_b64_tr_b16 v[90:91], v17 offset:37888
    s_add_u32 m0, s75, 67584
    s_nop 0
    buffer_load_dwordx4 v6, s[32:35], s77 offen  lds
    s_waitcnt lgkmcnt(7)
    v_mfma_f32_32x32x16_bf16 v[132:147], v[76:79], v[60:63], v[132:147]
    ds_read_b64_tr_b16 v[92:93], v18 offset:36864
    ds_read_b64_tr_b16 v[94:95], v18 offset:37888
    s_add_u32 m0, s75, 19456
    s_nop 0
    buffer_load_dwordx4 v11, s[36:39], s76 offen  lds
    s_waitcnt lgkmcnt(7)
    v_mfma_f32_32x32x16_bf16 v[148:163], v[80:83], v[60:63], v[148:163]
    ds_read_b64_tr_b16 v[96:97], v19 offset:36864
    ds_read_b64_tr_b16 v[98:99], v19 offset:37888
    s_add_u32 m0, s75, 68608
    s_nop 0
    buffer_load_dwordx4 v7, s[32:35], s77 offen  lds
    s_waitcnt lgkmcnt(6)
    v_mfma_f32_32x32x16_bf16 v[100:115], v[84:87], v[64:67], v[100:115]
    ds_read_b128 v[60:63], v14 offset:32768
    ds_read_b64_tr_b16 v[68:69], v16 offset:40960
    ds_read_b64_tr_b16 v[70:71], v16 offset:41984
    s_add_u32 m0, s85, 0
    s_nop 0
    buffer_load_dwordx4 v20, s[40:43], 0 offen offset:0  lds
    s_waitcnt lgkmcnt(7)
    v_mfma_f32_32x32x16_bf16 v[116:131], v[88:91], v[64:67], v[116:131]
    ds_read_b64_tr_b16 v[72:73], v17 offset:40960
    ds_read_b64_tr_b16 v[74:75], v17 offset:41984
    s_add_u32 m0, s85, 0
    s_nop 0
    buffer_load_dwordx4 v21, s[40:43], 0 offen offset:1024  lds
    s_waitcnt lgkmcnt(7)
    v_mfma_f32_32x32x16_bf16 v[132:147], v[92:95], v[64:67], v[132:147]
    ds_read_b64_tr_b16 v[76:77], v18 offset:40960
    ds_read_b64_tr_b16 v[78:79], v18 offset:41984
    s_add_u32 m0, s85, 0
    s_nop 0
    buffer_load_dwordx4 v22, s[40:43], 0 offen offset:2048  lds
    s_waitcnt lgkmcnt(7)
    v_mfma_f32_32x32x16_bf16 v[148:163], v[96:99], v[64:67], v[148:163]
    ds_read_b64_tr_b16 v[80:81], v19 offset:40960
    ds_read_b64_tr_b16 v[82:83], v19 offset:41984
    s_add_u32 m0, s85, 0
    s_nop 0
    buffer_load_dwordx4 v23, s[40:43], 0 offen offset:3072  lds
    s_waitcnt lgkmcnt(6)
    v_mfma_f32_32x32x16_bf16 v[100:115], v[68:71], v[60:63], v[100:115]
    ds_read_b128 v[64:67], v15 offset:32768
    ds_read_b64_tr_b16 v[84:85], v16 offset:45056
    ds_read_b64_tr_b16 v[86:87], v16 offset:46080
    s_add_u32 m0, s85, 4096
    s_nop 0
    buffer_load_dwordx4 v20, s[40:43], s84 offen offset:0  lds
    s_waitcnt lgkmcnt(7)
    v_mfma_f32_32x32x16_bf16 v[116:131], v[72:75], v[60:63], v[116:131]
    ds_read_b64_tr_b16 v[88:89], v17 offset:45056
    ds_read_b64_tr_b16 v[90:91], v17 offset:46080
    s_add_u32 m0, s85, 4096
    s_nop 0
    buffer_load_dwordx4 v21, s[40:43], s84 offen offset:1024  lds
    s_waitcnt lgkmcnt(7)
    v_mfma_f32_32x32x16_bf16 v[132:147], v[76:79], v[60:63], v[132:147]
    ds_read_b64_tr_b16 v[92:93], v18 offset:45056
    ds_read_b64_tr_b16 v[94:95], v18 offset:46080
    s_add_u32 m0, s85, 4096
    s_nop 0
    buffer_load_dwordx4 v22, s[40:43], s84 offen offset:2048  lds
    s_waitcnt lgkmcnt(7)
    v_mfma_f32_32x32x16_bf16 v[148:163], v[80:83], v[60:63], v[148:163]
    ds_read_b64_tr_b16 v[96:97], v19 offset:45056
    ds_read_b64_tr_b16 v[98:99], v19 offset:46080
    s_add_u32 m0, s85, 4096
    s_nop 0
    buffer_load_dwordx4 v23, s[40:43], s84 offen offset:3072  lds
    s_waitcnt lgkmcnt(6)
    v_mfma_f32_32x32x16_bf16 v[100:115], v[84:87], v[64:67], v[100:115]
    s_waitcnt lgkmcnt(4)
    v_mfma_f32_32x32x16_bf16 v[116:131], v[88:91], v[64:67], v[116:131]
    s_waitcnt lgkmcnt(0)
    s_waitcnt vmcnt(16)
    s_barrier
    ds_read_b128 v[60:63], v12 offset:0
    ds_read_b64_tr_b16 v[68:69], v16 offset:0
    ds_read_b64_tr_b16 v[70:71], v16 offset:1024
    s_add_u32 s91, s91, 1
    s_cmp_eq_u32 s91, 9
    s_cselect_b32 s91, 0, s91
    s_lshl_b32 s76, s91, 19
    s_lshl_b32 s77, s91, 7
    s_add_u32 m0, s75, 32768
    s_nop 0
    buffer_load_dwordx4 v8, s[36:39], s76 offen  lds
    v_mfma_f32_32x32x16_bf16 v[132:147], v[92:95], v[64:67], v[132:147]
    ds_read_b64_tr_b16 v[72:73], v17 offset:0
    ds_read_b64_tr_b16 v[74:75], v17 offset:1024
    ds_read_b64_tr_b16 v[76:77], v18 offset:0
    s_add_u32 m0, s75, 81920
    s_nop 0
    buffer_load_dwordx4 v4, s[32:35], s77 offen  lds
    v_mfma_f32_32x32x16_bf16 v[148:163], v[96:99], v[64:67], v[148:163]
    ds_read_b64_tr_b16 v[78:79], v18 offset:1024
    ds_read_b64_tr_b16 v[80:81], v19 offset:0
    ds_read_b64_tr_b16 v[82:83], v19 offset:1024
    s_waitcnt lgkmcnt(6)
    v_mfma_f32_32x32x16_bf16 v[100:115], v[68:71], v[60:63], v[100:115]
    ds_read_b128 v[64:67], v13 offset:0
    ds_read_b64_tr_b16 v[84:85], v16 offset:4096
    ds_read_b64_tr_b16 v[86:87], v16 offset:5120
    s_waitcnt lgkmcnt(7)
    v_mfma_f32_32x32x16_bf16 v[116:131], v[72:75], v[60:63], v[116:131]
    ds_read_b64_tr_b16 v[88:89], v17 offset:4096
    ds_read_b64_tr_b16 v[90:91], v17 offset:5120
    s_add_u32 m0, s75, 33792
    s_nop 0
    buffer_load_dwordx4 v9, s[36:39], s76 offen  lds
    s_waitcnt lgkmcnt(7)
    v_mfma_f32_32x32x16_bf16 v[132:147], v[76:79], v[60:63], v[132:147]
    ds_read_b64_tr_b16 v[92:93], v18 offset:4096
    ds_read_b64_tr_b16 v[94:95], v18 offset:5120
    s_add_u32 m0, s75, 82944
    s_nop 0
    buffer_load_dwordx4 v5, s[32:35], s77 offen  lds
    s_waitcnt lgkmcnt(7)
    v_mfma_f32_32x32x16_bf16 v[148:163], v[80:83], v[60:63], v[148:163]
    ds_read_b64_tr_b16 v[96:97], v19 offset:4096
    ds_read_b64_tr_b16 v[98:99], v19 offset:5120
    s_waitcnt lgkmcnt(6)
    v_mfma_f32_32x32x16_bf16 v[100:115], v[84:87], v[64:67], v[100:115]
    ds_read_b128 v[60:63], v14 offset:0
    ds_read_b64_tr_b16 v[68:69], v16 offset:8192
    ds_read_b64_tr_b16 v[70:71], v16 offset:9216
    s_waitcnt lgkmcnt(7)
    v_mfma_f32_32x32x16_bf16 v[116:131], v[88:91], v[64:67], v[116:131]
    ds_read_b64_tr_b16 v[72:73], v17 offset:8192
    ds_read_b64_tr_b16 v[74:75], v17 offset:9216
    s_add_u32 m0, s75, 34816
    s_nop 0
    buffer_load_dwordx4 v10, s[36:39], s76 offen  lds
    s_waitcnt lgkmcnt(7)
    v_mfma_f32_32x32x16_bf16 v[132:147], v[92:95], v[64:67], v[132:147]
    ds_read_b64_tr_b16 v[76:77], v18 offset:8192
    ds_read_b64_tr_b16 v[78:79], v18 offset:9216
    s_add_u32 m0, s75, 83968
    s_nop 0
    buffer_load_dwordx4 v6, s[32:35], s77 offen  lds
    s_waitcnt lgkmcnt(7)
    v_mfma_f32_32x32x16_bf16 v[148:163], v[96:99], v[64:67], v[148:163]
    ds_read_b64_tr_b16 v[80:81], v19 offset:8192
    ds_read_b64_tr_b16 v[82:83], v19 offset:9216
    s_waitcnt lgkmcnt(6)
    v_mfma_f32_32x32x16_bf16 v[100:115], v[68:71], v[60:63], v[100:115]
    ds_read_b128 v[64:67], v15 offset:0
    ds_read_b64_tr_b16 v[84:85], v16 offset:12288
    ds_read_b64_tr_b16 v[86:87], v16 offset:13312
    s_waitcnt lgkmcnt(7)
    v_mfma_f32_32x32x16_bf16 v[116:131], v[72:75], v[60:63], v[116:131]
    ds_read_b64_tr_b16 v[88:89], v17 offset:12288
    ds_read_b64_tr_b16 v[90:91], v17 offset:13312
    s_add_u32 m0, s75, 35840
    s_nop 0
    buffer_load_dwordx4 v11, s[36:39], s76 offen  lds
    s_waitcnt lgkmcnt(7)
    v_mfma_f32_32x32x16_bf16 v[132:147], v[76:79], v[60:63], v[132:147]
    ds_read_b64_tr_b16 v[92:93], v18 offset:12288
    ds_read_b64_tr_b16 v[94:95], v18 offset:13312
    s_add_u32 m0, s75, 84992
    s_nop 0
    buffer_load_dwordx4 v7, s[32:35], s77 offen  lds
    s_waitcnt lgkmcnt(7)
    v_mfma_f32_32x32x16_bf16 v[148:163], v[80:83], v[60:63], v[148:163]
    ds_read_b64_tr_b16 v[96:97], v19 offset:12288
    ds_read_b64_tr_b16 v[98:99], v19 offset:13312
    s_waitcnt lgkmcnt(6)
    v_mfma_f32_32x32x16_bf16 v[100:115], v[84:87], v[64:67], v[100:115]
    s_waitcnt lgkmcnt(4)
    v_mfma_f32_32x32x16_bf16 v[116:131], v[88:91], v[64:67], v[116:131]
    s_waitcnt lgkmcnt(0)
    s_waitcnt vmcnt(16)
    s_barrier
    ds_read_b128 v[60:63], v12 offset:16384
    ds_read_b64_tr_b16 v[68:69], v16 offset:16384
    ds_read_b64_tr_b16 v[70:71], v16 offset:17408
    s_add_u32 s91, s91, 1
    s_cmp_eq_u32 s91, 9
    s_cselect_b32 s91, 0, s91
    s_lshl_b32 s76, s91, 19
    s_lshl_b32 s77, s91, 7
    s_add_u32 m0, s75, 0
    s_nop 0
    buffer_load_dwordx4 v8, s[36:39], s76 offen  lds
    s_add_u32 m0, s75, 49152
    s_nop 0
    buffer_load_dwordx4 v4, s[32:35], s77 offen  lds
    v_mfma_f32_32x32x16_bf16 v[132:147], v[92:95], v[64:67], v[132:147]
    ds_read_b64_tr_b16 v[72:73], v17 offset:16384
    ds_read_b64_tr_b16 v[74:75], v17 offset:17408
    ds_read_b64_tr_b16 v[76:77], v18 offset:16384
    s_add_u32 m0, s75, 1024
    s_nop 0
    buffer_load_dwordx4 v9, s[36:39], s76 offen  lds
    v_mfma_f32_32x32x16_bf16 v[148:163], v[96:99], v[64:67], v[148:163]
    ds_read_b64_tr_b16 v[78:79], v18 offset:17408
    ds_read_b64_tr_b16 v[80:81], v19 offset:16384
    ds_read_b64_tr_b16 v[82:83], v19 offset:17408
    s_add_u32 m0, s75, 50176
    s_nop 0
    buffer_load_dwordx4 v5, s[32:35], s77 offen  lds
    s_waitcnt lgkmcnt(6)
    v_mfma_f32_32x32x16_bf16 v[100:115], v[68:71], v[60:63], v[100:115]
    ds_read_b128 v[64:67], v13 offset:16384
    ds_read_b64_tr_b16 v[84:85], v16 offset:20480
    ds_read_b64_tr_b16 v[86:87], v16 offset:21504
    s_add_u32 m0, s75, 2048
    s_nop 0
    buffer_load_dwordx4 v10, s[36:39], s76 offen  lds
    s_waitcnt lgkmcnt(7)
    v_mfma_f32_32x32x16_bf16 v[116:131], v[72:75], v[60:63], v[116:131]
    ds_read_b64_tr_b16 v[88:89], v17 offset:20480
    ds_read_b64_tr_b16 v[90:91], v17 offset:21504
    s_add_u32 m0, s75, 51200
    s_nop 0
    buffer_load_dwordx4 v6, s[32:35], s77 offen  lds
    s_waitcnt lgkmcnt(7)
    v_mfma_f32_32x32x16_bf16 v[132:147], v[76:79], v[60:63], v[132:147]
    ds_read_b64_tr_b16 v[92:93], v18 offset:20480
    ds_read_b64_tr_b16 v[94:95], v18 offset:21504
    s_add_u32 m0, s75, 3072
    s_nop 0
    buffer_load_dwordx4 v11, s[36:39], s76 offen  lds
    s_waitcnt lgkmcnt(7)
    v_mfma_f32_32x32x16_bf16 v[148:163], v[80:83], v[60:63], v[148:163]
    ds_read_b64_tr_b16 v[96:97], v19 offset:20480
    ds_read_b64_tr_b16 v[98:99], v19 offset:21504
    s_add_u32 m0, s75, 52224
    s_nop 0
    buffer_load_dwordx4 v7, s[32:35], s77 offen  lds
    s_waitcnt lgkmcnt(6)
    v_mfma_f32_32x32x16_bf16 v[100:115], v[84:87], v[64:67], v[100:115]
    ds_read_b128 v[60:63], v14 offset:16384
    ds_read_b64_tr_b16 v[68:69], v16 offset:24576
    ds_read_b64_tr_b16 v[70:71], v16 offset:25600
    s_add_u32 m0, s85, 8192
    s_nop 0
    buffer_load_dwordx4 v24, s[44:47], 0 offen offset:0  lds
    s_waitcnt lgkmcnt(7)
    v_mfma_f32_32x32x16_bf16 v[116:131], v[88:91], v[64:67], v[116:131]
    ds_read_b64_tr_b16 v[72:73], v17 offset:24576
    ds_read_b64_tr_b16 v[74:75], v17 offset:25600
    s_add_u32 m0, s85, 8192
    s_nop 0
    buffer_load_dwordx4 v24, s[44:47], 0 offen offset:1024  lds
    s_waitcnt lgkmcnt(7)
    v_mfma_f32_32x32x16_bf16 v[132:147], v[92:95], v[64:67], v[132:147]
    ds_read_b64_tr_b16 v[76:77], v18 offset:24576
    ds_read_b64_tr_b16 v[78:79], v18 offset:25600
    s_add_u32 m0, s85, 8192
    s_nop 0
    buffer_load_dwordx4 v24, s[44:47], 0 offen offset:2048  lds
    s_waitcnt lgkmcnt(7)
    v_mfma_f32_32x32x16_bf16 v[148:163], v[96:99], v[64:67], v[148:163]
    ds_read_b64_tr_b16 v[80:81], v19 offset:24576
    ds_read_b64_tr_b16 v[82:83], v19 offset:25600
    s_add_u32 m0, s85, 8192
    s_nop 0
    buffer_load_dwordx4 v24, s[44:47], 0 offen offset:3072  lds
    s_waitcnt lgkmcnt(6)
    v_mfma_f32_32x32x16_bf16 v[100:115], v[68:71], v[60:63], v[100:115]
    ds_read_b128 v[64:67], v15 offset:16384
    ds_read_b64_tr_b16 v[84:85], v16 offset:28672
    ds_read_b64_tr_b16 v[86:87], v16 offset:29696
    s_add_u32 m0, s85, 12288
    s_nop 0
    buffer_load_dwordx4 v24, s[44:47], s84 offen offset:0  lds
    s_waitcnt lgkmcnt(7)
    v_mfma_f32_32x32x16_bf16 v[116:131], v[72:75], v[60:63], v[116:131]
    ds_read_b64_tr_b16 v[88:89], v17 offset:28672
    ds_read_b64_tr_b16 v[90:91], v17 offset:29696
    s_add_u32 m0, s85, 12288
    s_nop 0
    buffer_load_dwordx4 v24, s[44:47], s84 offen offset:1024  lds
    s_waitcnt lgkmcnt(7)
    v_mfma_f32_32x32x16_bf16 v[132:147], v[76:79], v[60:63], v[132:147]
    ds_read_b64_tr_b16 v[92:93], v18 offset:28672
    ds_read_b64_tr_b16 v[94:95], v18 offset:29696
    s_add_u32 m0, s85, 12288
    s_nop 0
    buffer_load_dwordx4 v24, s[44:47], s84 offen offset:2048  lds
    s_waitcnt lgkmcnt(7)
    v_mfma_f32_32x32x16_bf16 v[148:163], v[80:83], v[60:63], v[148:163]
    ds_read_b64_tr_b16 v[96:97], v19 offset:28672
    ds_read_b64_tr_b16 v[98:99], v19 offset:29696
    s_add_u32 m0, s85, 12288
    s_nop 0
    buffer_load_dwordx4 v24, s[44:47], s84 offen offset:3072  lds
    s_waitcnt lgkmcnt(6)
    v_mfma_f32_32x32x16_bf16 v[100:115], v[84:87], v[64:67], v[100:115]
    s_waitcnt lgkmcnt(4)
    v_mfma_f32_32x32x16_bf16 v[116:131], v[88:91], v[64:67], v[116:131]
    s_waitcnt lgkmcnt(0)
    s_waitcnt vmcnt(16)
    s_barrier
    ds_read_b128 v[60:63], v12 offset:32768
    ds_read_b64_tr_b16 v[68:69], v16 offset:32768
    ds_read_b64_tr_b16 v[70:71], v16 offset:33792
    s_add_u32 s91, s91, 1
    s_cmp_eq_u32 s91, 9
    s_cselect_b32 s91, 0, s91
    s_lshl_b32 s76, s91, 19
    s_lshl_b32 s77, s91, 7
    s_add_u32 m0, s75, 16384
    s_nop 0
    buffer_load_dwordx4 v8, s[36:39], s76 offen  lds
    v_mfma_f32_32x32x16_bf16 v[132:147], v[92:95], v[64:67], v[132:147]
    ds_read_b64_tr_b16 v[72:73], v17 offset:32768
    ds_read_b64_tr_b16 v[74:75], v17 offset:33792
    ds_read_b64_tr_b16 v[76:77], v18 offset:32768
    s_add_u32 m0, s75, 65536
    s_nop 0
    buffer_load_dwordx4 v4, s[32:35], s77 offen  lds
    v_mfma_f32_32x32x16_bf16 v[148:163], v[96:99], v[64:67], v[148:163]
    ds_read_b64_tr_b16 v[78:79], v18 offset:33792
    ds_read_b64_tr_b16 v[80:81], v19 offset:32768
    ds_read_b64_tr_b16 v[82:83], v19 offset:33792
    s_waitcnt lgkmcnt(6)
    v_mfma_f32_32x32x16_bf16 v[100:115], v[68:71], v[60:63], v[100:115]
    ds_read_b128 v[64:67], v13 offset:32768
    ds_read_b64_tr_b16 v[84:85], v16 offset:36864
    ds_read_b64_tr_b16 v[86:87], v16 offset:37888
    v_xor_b32 v50, 0, v25
    ds_read_b128 a[72:75], v50
    v_xor_b32 v51, 32, v25
    ds_read_b128 a[76:79], v51
    s_waitcnt lgkmcnt(9)
    v_mfma_f32_32x32x16_bf16 v[116:131], v[72:75], v[60:63], v[116:131]
    ds_read_b64_tr_b16 v[88:89], v17 offset:36864
    ds_read_b64_tr_b16 v[90:91], v17 offset:37888
    v_xor_b32 v50, 64, v25
    ds_read_b128 a[80:83], v50
    v_xor_b32 v51, 96, v25
    ds_read_b128 a[84:87], v51
    s_add_u32 m0, s75, 17408
    s_nop 0
    buffer_load_dwordx4 v9, s[36:39], s76 offen  lds
    s_waitcnt lgkmcnt(11)
    v_mfma_f32_32x32x16_bf16 v[132:147], v[76:79], v[60:63], v[132:147]
    ds_read_b64_tr_b16 v[92:93], v18 offset:36864
    ds_read_b64_tr_b16 v[94:95], v18 offset:37888
    v_xor_b32 v50, 128, v25
    ds_read_b128 a[88:91], v50
    v_xor_b32 v51, 160, v25
    ds_read_b128 a[92:95], v51
    s_add_u32 m0, s75, 66560
    s_nop 0
    buffer_load_dwordx4 v5, s[32:35], s77 offen  lds
    s_waitcnt lgkmcnt(13)
    v_mfma_f32_32x32x16_bf16 v[148:163], v[80:83], v[60:63], v[148:163]
    ds_read_b64_tr_b16 v[96:97], v19 offset:36864
    ds_read_b64_tr_b16 v[98:99], v19 offset:37888
    v_xor_b32 v50, 192, v25
    ds_read_b128 a[96:99], v50
    v_xor_b32 v51, 224, v25
    ds_read_b128 a[100:103], v51
    s_waitcnt lgkmcnt(14)
    v_mfma_f32_32x32x16_bf16 v[100:115], v[84:87], v[64:67], v[100:115]
    ds_read_b128 v[60:63], v14 offset:32768
    ds_read_b64_tr_b16 v[68:69], v16 offset:40960
    ds_read_b64_tr_b16 v[70:71], v16 offset:41984
    s_waitcnt lgkmcnt(13)
    v_mfma_f32_32x32x16_bf16 v[116:131], v[88:91], v[64:67], v[116:131]
    ds_read_b64_tr_b16 v[72:73], v17 offset:40960
    ds_read_b64_tr_b16 v[74:75], v17 offset:41984
    s_add_u32 m0, s75, 18432
    s_nop 0
    buffer_load_dwordx4 v10, s[36:39], s76 offen  lds
    s_waitcnt lgkmcnt(11)
    v_mfma_f32_32x32x16_bf16 v[132:147], v[92:95], v[64:67], v[132:147]
    ds_read_b64_tr_b16 v[76:77], v18 offset:40960
    ds_read_b64_tr_b16 v[78:79], v18 offset:41984
    s_add_u32 m0, s75, 67584
    s_nop 0
    buffer_load_dwordx4 v6, s[32:35], s77 offen  lds
    s_waitcnt lgkmcnt(9)
    v_mfma_f32_32x32x16_bf16 v[148:163], v[96:99], v[64:67], v[148:163]
    ds_read_b64_tr_b16 v[80:81], v19 offset:40960
    ds_read_b64_tr_b16 v[82:83], v19 offset:41984
    s_waitcnt lgkmcnt(6)
    v_mfma_f32_32x32x16_bf16 v[100:115], v[68:71], v[60:63], v[100:115]
    ds_read_b128 v[64:67], v15 offset:32768
    ds_read_b64_tr_b16 v[84:85], v16 offset:45056
    ds_read_b64_tr_b16 v[86:87], v16 offset:46080
    s_add_u32 m0, s75, 19456
    s_nop 0
    buffer_load_dwordx4 v11, s[36:39], s76 offen  lds
    s_waitcnt lgkmcnt(7)
    v_mfma_f32_32x32x16_bf16 v[116:131], v[72:75], v[60:63], v[116:131]
    ds_read_b64_tr_b16 v[88:89], v17 offset:45056
    ds_read_b64_tr_b16 v[90:91], v17 offset:46080
    s_waitcnt lgkmcnt(7)
    v_mfma_f32_32x32x16_bf16 v[132:147], v[76:79], v[60:63], v[132:147]
    ds_read_b64_tr_b16 v[92:93], v18 offset:45056
    ds_read_b64_tr_b16 v[94:95], v18 offset:46080
    s_add_u32 m0, s75, 68608
    s_nop 0
    buffer_load_dwordx4 v7, s[32:35], s77 offen  lds
    s_waitcnt lgkmcnt(7)
    v_mfma_f32_32x32x16_bf16 v[148:163], v[80:83], v[60:63], v[148:163]
    ds_read_b64_tr_b16 v[96:97], v19 offset:45056
    ds_read_b64_tr_b16 v[98:99], v19 offset:46080
    buffer_load_dword v58, off, s[60:63], 0
    s_waitcnt lgkmcnt(6)
    v_mfma_f32_32x32x16_bf16 v[100:115], v[84:87], v[64:67], v[100:115]
    s_waitcnt lgkmcnt(4)
    v_mfma_f32_32x32x16_bf16 v[116:131], v[88:91], v[64:67], v[116:131]
    s_waitcnt lgkmcnt(0)
    s_waitcnt vmcnt(17)
    s_barrier
    ds_read_b128 v[60:63], v12 offset:0
    ds_read_b64_tr_b16 v[68:69], v16 offset:0
    ds_read_b64_tr_b16 v[70:71], v16 offset:1024
    s_add_u32 s91, s91, 1
    s_cmp_eq_u32 s91, 9
    s_cselect_b32 s91, 0, s91
    s_lshl_b32 s76, s91, 19
    s_lshl_b32 s77, s91, 7
    s_add_u32 m0, s75, 32768
    s_nop 0
    buffer_load_dwordx4 v8, s[36:39], s76 offen  lds
    v_mfma_f32_32x32x16_bf16 v[132:147], v[92:95], v[64:67], v[132:147]
    ds_read_b64_tr_b16 v[72:73], v17 offset:0
    ds_read_b64_tr_b16 v[74:75], v17 offset:1024
    ds_read_b64_tr_b16 v[76:77], v18 offset:0
    s_add_u32 m0, s75, 81920
    s_nop 0
    buffer_load_dwordx4 v4, s[32:35], s77 offen  lds
    v_mfma_f32_32x32x16_bf16 v[148:163], v[96:99], v[64:67], v[148:163]
    ds_read_b64_tr_b16 v[78:79], v18 offset:1024
    ds_read_b64_tr_b16 v[80:81], v19 offset:0
    ds_read_b64_tr_b16 v[82:83], v19 offset:1024
    s_waitcnt lgkmcnt(6)
    v_mfma_f32_32x32x16_bf16 v[100:115], v[68:71], v[60:63], v[100:115]
    ds_read_b128 v[64:67], v13 offset:0
    ds_read_b64_tr_b16 v[84:85], v16 offset:4096
    ds_read_b64_tr_b16 v[86:87], v16 offset:5120
    s_waitcnt lgkmcnt(7)
    v_mfma_f32_32x32x16_bf16 v[116:131], v[72:75], v[60:63], v[116:131]
    ds_read_b64_tr_b16 v[88:89], v17 offset:4096
    ds_read_b64_tr_b16 v[90:91], v17 offset:5120
    s_add_u32 m0, s75, 33792
    s_nop 0
    buffer_load_dwordx4 v9, s[36:39], s76 offen  lds
    s_waitcnt lgkmcnt(7)
    v_mfma_f32_32x32x16_bf16 v[132:147], v[76:79], v[60:63], v[132:147]
    ds_read_b64_tr_b16 v[92:93], v18 offset:4096
    ds_read_b64_tr_b16 v[94:95], v18 offset:5120
    s_add_u32 m0, s75, 82944
    s_nop 0
    buffer_load_dwordx4 v5, s[32:35], s77 offen  lds
    s_waitcnt lgkmcnt(7)
    v_mfma_f32_32x32x16_bf16 v[148:163], v[80:83], v[60:63], v[148:163]
    ds_read_b64_tr_b16 v[96:97], v19 offset:4096
    ds_read_b64_tr_b16 v[98:99], v19 offset:5120
    s_waitcnt lgkmcnt(6)
    v_mfma_f32_32x32x16_bf16 v[100:115], v[84:87], v[64:67], v[100:115]
    ds_read_b128 v[60:63], v14 offset:0
    ds_read_b64_tr_b16 v[68:69], v16 offset:8192
    ds_read_b64_tr_b16 v[70:71], v16 offset:9216
    s_add_u32 m0, s75, 34816
    s_nop 0
    buffer_load_dwordx4 v10, s[36:39], s76 offen  lds
    s_waitcnt lgkmcnt(7)
    v_mfma_f32_32x32x16_bf16 v[116:131], v[88:91], v[64:67], v[116:131]
    ds_read_b64_tr_b16 v[72:73], v17 offset:8192
    ds_read_b64_tr_b16 v[74:75], v17 offset:9216
    s_waitcnt lgkmcnt(7)
    v_mfma_f32_32x32x16_bf16 v[132:147], v[92:95], v[64:67], v[132:147]
    ds_read_b64_tr_b16 v[76:77], v18 offset:8192
    ds_read_b64_tr_b16 v[78:79], v18 offset:9216
    s_add_u32 m0, s75, 83968
    s_nop 0
    buffer_load_dwordx4 v6, s[32:35], s77 offen  lds
    s_waitcnt lgkmcnt(7)
    v_mfma_f32_32x32x16_bf16 v[148:163], v[96:99], v[64:67], v[148:163]
    ds_read_b64_tr_b16 v[80:81], v19 offset:8192
    ds_read_b64_tr_b16 v[82:83], v19 offset:9216
    s_add_u32 m0, s75, 35840
    s_nop 0
    buffer_load_dwordx4 v11, s[36:39], s76 offen  lds
    s_waitcnt lgkmcnt(6)
    v_mfma_f32_32x32x16_bf16 v[100:115], v[68:71], v[60:63], v[100:115]
    ds_read_b128 v[64:67], v15 offset:0
    ds_read_b64_tr_b16 v[84:85], v16 offset:12288
    ds_read_b64_tr_b16 v[86:87], v16 offset:13312
    s_waitcnt vmcnt(7)
    s_mov_b32 s90, 0
L_tagpoll_3:
    v_readfirstlane_b32 s29, v58
    s_add_u32 s90, s90, 1
    s_nop 2
    s_cmp_lg_u32 s29, 0
    s_cbranch_scc1 L_tagok_4
    s_cmp_lt_u32 s90, 524288
    s_cbranch_scc0 L_tagok_4
    buffer_load_dword v58, off, s[60:63], 0 sc1
    s_waitcnt vmcnt(0)
    s_branch L_tagpoll_3
L_tagok_4:
    s_add_u32 m0, s75, 84992
    s_nop 0
    buffer_load_dwordx4 v7, s[32:35], s77 offen  lds
    s_waitcnt lgkmcnt(7)
    v_mfma_f32_32x32x16_bf16 v[116:131], v[72:75], v[60:63], v[116:131]
    ds_read_b64_tr_b16 v[88:89], v17 offset:12288
    ds_read_b64_tr_b16 v[90:91], v17 offset:13312
    s_waitcnt lgkmcnt(7)
    v_mfma_f32_32x32x16_bf16 v[132:147], v[76:79], v[60:63], v[132:147]
    ds_read_b64_tr_b16 v[92:93], v18 offset:12288
    ds_read_b64_tr_b16 v[94:95], v18 offset:13312
    buffer_load_dword v1, v49, s[48:51], 0 offen
    s_waitcnt lgkmcnt(7)
    v_mfma_f32_32x32x16_bf16 v[148:163], v[80:83], v[60:63], v[148:163]
    ds_read_b64_tr_b16 v[96:97], v19 offset:12288
    ds_read_b64_tr_b16 v[98:99], v19 offset:13312
    s_mov_b64 exec, 0xff
    buffer_load_dword v1, v49, s[48:51], s96 offen
    s_mov_b64 exec, -1
    s_waitcnt lgkmcnt(6)
    v_mfma_f32_32x32x16_bf16 v[100:115], v[84:87], v[64:67], v[100:115]
    s_waitcnt lgkmcnt(4)
    v_mfma_f32_32x32x16_bf16 v[116:131], v[88:91], v[64:67], v[116:131]
    s_waitcnt lgkmcnt(0)
    s_barrier
    ds_read_b128 v[60:63], v12 offset:16384
    ds_read_b64_tr_b16 v[68:69], v16 offset:16384
    ds_read_b64_tr_b16 v[70:71], v16 offset:17408
    v_mfma_f32_32x32x16_bf16 v[132:147], v[92:95], v[64:67], v[132:147]
    ds_read_b64_tr_b16 v[72:73], v17 offset:16384
    ds_read_b64_tr_b16 v[74:75], v17 offset:17408
    ds_read_b64_tr_b16 v[76:77], v18 offset:16384
    v_mfma_f32_32x32x16_bf16 v[148:163], v[96:99], v[64:67], v[148:163]
    ds_read_b64_tr_b16 v[78:79], v18 offset:17408
    ds_read_b64_tr_b16 v[80:81], v19 offset:16384
    ds_read_b64_tr_b16 v[82:83], v19 offset:17408
    s_waitcnt lgkmcnt(6)
    v_mfma_f32_32x32x16_bf16 v[100:115], v[68:71], v[60:63], v[100:115]
    ds_read_b128 v[64:67], v13 offset:16384
    ds_read_b64_tr_b16 v[84:85], v16 offset:20480
    ds_read_b64_tr_b16 v[86:87], v16 offset:21504
    ds_read_b64_tr_b16 a[104:105], v28 offset:0
    ds_read_b64_tr_b16 a[106:107], v28 offset:2048
    s_waitcnt lgkmcnt(9)
    v_mfma_f32_32x32x16_bf16 v[116:131], v[72:75], v[60:63], v[116:131]
    ds_read_b64_tr_b16 v[88:89], v17 offset:20480
    ds_read_b64_tr_b16 v[90:91], v17 offset:21504
    ds_read_b64_tr_b16 a[108:109], v29 offset:0
    ds_read_b64_tr_b16 a[110:111], v29 offset:2048
    s_waitcnt lgkmcnt(11)
    v_mfma_f32_32x32x16_bf16 v[132:147], v[76:79], v[60:63], v[132:147]
    ds_read_b64_tr_b16 v[92:93], v18 offset:20480
    ds_read_b64_tr_b16 v[94:95], v18 offset:21504
    ds_read_b64_tr_b16 a[112:113], v30 offset:0
    ds_read_b64_tr_b16 a[114:115], v30 offset:2048
    s_waitcnt lgkmcnt(13)
    v_mfma_f32_32x32x16_bf16 v[148:163], v[80:83], v[60:63], v[148:163]
    ds_read_b64_tr_b16 v[96:97], v19 offset:20480
    ds_read_b64_tr_b16 v[98:99], v19 offset:21504
    ds_read_b64_tr_b16 a[116:117], v31 offset:0
    ds_read_b64_tr_b16 a[118:119], v31 offset:2048
    s_waitcnt lgkmcnt(14)
    v_mfma_f32_32x32x16_bf16 v[100:115], v[84:87], v[64:67], v[100:115]
    ds_read_b128 v[60:63], v14 offset:16384
    ds_read_b64_tr_b16 v[68:69], v16 offset:24576
    ds_read_b64_tr_b16 v[70:71], v16 offset:25600
    ds_read_b64_tr_b16 a[120:121], v28 offset:4096
    ds_read_b64_tr_b16 a[122:123], v28 offset:6144
    s_waitcnt lgkmcnt(15)
    v_mfma_f32_32x32x16_bf16 v[116:131], v[88:91], v[64:67], v[116:131]
    ds_read_b64_tr_b16 v[72:73], v17 offset:24576
    ds_read_b64_tr_b16 v[74:75], v17 offset:25600
    ds_read_b64_tr_b16 a[124:125], v29 offset:4096
    ds_read_b64_tr_b16 a[126:127], v29 offset:6144
    s_waitcnt lgkmcnt(15)
    v_mfma_f32_32x32x16_bf16 v[132:147], v[92:95], v[64:67], v[132:147]
    ds_read_b64_tr_b16 v[76:77], v18 offset:24576
    ds_read_b64_tr_b16 v[78:79], v18 offset:25600
    ds_read_b64_tr_b16 a[128:129], v30 offset:4096
    ds_read_b64_tr_b16 a[130:131], v30 offset:6144
    s_waitcnt lgkmcnt(15)
    v_mfma_f32_32x32x16_bf16 v[148:163], v[96:99], v[64:67], v[148:163]
    ds_read_b64_tr_b16 v[80:81], v19 offset:24576
    ds_read_b64_tr_b16 v[82:83], v19 offset:25600
    ds_read_b64_tr_b16 a[132:133], v31 offset:4096
    ds_read_b64_tr_b16 a[134:135], v31 offset:6144
    s_waitcnt lgkmcnt(14)
    v_mfma_f32_32x32x16_bf16 v[100:115], v[68:71], v[60:63], v[100:115]
    ds_read_b128 v[64:67], v15 offset:16384
    ds_read_b64_tr_b16 v[84:85], v16 offset:28672
    ds_read_b64_tr_b16 v[86:87], v16 offset:29696
    s_xor_b32 s78, s82, 1
    s_lshl_b32 s33, s78, 11
    s_xor_b32 s78, s82, 2
    s_lshl_b32 s34, s78, 11
    s_xor_b32 s78, s82, 3
    s_lshl_b32 s35, s78, 11
    s_mov_b32 s91, 8192
    s_mov_b32 s87, 0x3e0293ee
    s_waitcnt lgkmcnt(13)
    v_mfma_f32_32x32x16_bf16 v[116:131], v[72:75], v[60:63], v[116:131]
    ds_read_b64_tr_b16 v[88:89], v17 offset:28672
    ds_read_b64_tr_b16 v[90:91], v17 offset:29696
    s_waitcnt lgkmcnt(11)
    v_mfma_f32_32x32x16_bf16 v[132:147], v[76:79], v[60:63], v[132:147]
    ds_read_b64_tr_b16 v[92:93], v18 offset:28672
    ds_read_b64_tr_b16 v[94:95], v18 offset:29696
    s_waitcnt lgkmcnt(9)
    v_mfma_f32_32x32x16_bf16 v[148:163], v[80:83], v[60:63], v[148:163]
    ds_read_b64_tr_b16 v[96:97], v19 offset:28672
    ds_read_b64_tr_b16 v[98:99], v19 offset:29696
    s_waitcnt lgkmcnt(6)
    v_mfma_f32_32x32x16_bf16 v[100:115], v[84:87], v[64:67], v[100:115]
    s_waitcnt lgkmcnt(4)
    v_mfma_f32_32x32x16_bf16 v[116:131], v[88:91], v[64:67], v[116:131]
    s_waitcnt lgkmcnt(0)
    s_waitcnt vmcnt(2)
    s_barrier
    ds_read_b128 v[60:63], v12 offset:32768
    ds_read_b64_tr_b16 v[68:69], v16 offset:32768
    ds_read_b64_tr_b16 v[70:71], v16 offset:33792
    v_mfma_f32_32x32x16_bf16 v[132:147], v[92:95], v[64:67], v[132:147]
    ds_read_b64_tr_b16 v[72:73], v17 offset:32768
    ds_read_b64_tr_b16 v[74:75], v17 offset:33792
    ds_read_b64_tr_b16 v[76:77], v18 offset:32768
    v_mfma_f32_32x32x16_bf16 v[148:163], v[96:99], v[64:67], v[148:163]
    ds_read_b64_tr_b16 v[78:79], v18 offset:33792
    ds_read_b64_tr_b16 v[80:81], v19 offset:32768
    ds_read_b64_tr_b16 v[82:83], v19 offset:33792
    s_waitcnt lgkmcnt(6)
    v_mfma_f32_32x32x16_bf16 v[100:115], v[68:71], v[60:63], v[100:115]
    ds_read_b128 v[64:67], v13 offset:32768
    ds_read_b64_tr_b16 v[84:85], v16 offset:36864
    ds_read_b64_tr_b16 v[86:87], v16 offset:37888
    s_waitcnt lgkmcnt(7)
    v_mfma_f32_32x32x16_bf16 v[116:131], v[72:75], v[60:63], v[116:131]
    ds_read_b64_tr_b16 v[88:89], v17 offset:36864
    ds_read_b64_tr_b16 v[90:91], v17 offset:37888
    s_waitcnt lgkmcnt(7)
    v_mfma_f32_32x32x16_bf16 v[132:147], v[76:79], v[60:63], v[132:147]
    ds_read_b64_tr_b16 v[92:93], v18 offset:36864
    ds_read_b64_tr_b16 v[94:95], v18 offset:37888
    s_waitcnt lgkmcnt(7)
    v_mfma_f32_32x32x16_bf16 v[148:163], v[80:83], v[60:63], v[148:163]
    ds_read_b64_tr_b16 v[96:97], v19 offset:36864
    ds_read_b64_tr_b16 v[98:99], v19 offset:37888
    s_waitcnt lgkmcnt(6)
    v_mfma_f32_32x32x16_bf16 v[100:115], v[84:87], v[64:67], v[100:115]
    ds_read_b128 v[60:63], v14 offset:32768
    ds_read_b64_tr_b16 v[68:69], v16 offset:40960
    ds_read_b64_tr_b16 v[70:71], v16 offset:41984
    s_waitcnt lgkmcnt(7)
    v_mfma_f32_32x32x16_bf16 v[116:131], v[88:91], v[64:67], v[116:131]
    ds_read_b64_tr_b16 v[72:73], v17 offset:40960
    ds_read_b64_tr_b16 v[74:75], v17 offset:41984
    s_waitcnt lgkmcnt(7)
    v_mfma_f32_32x32x16_bf16 v[132:147], v[92:95], v[64:67], v[132:147]
    ds_read_b64_tr_b16 v[76:77], v18 offset:40960
    ds_read_b64_tr_b16 v[78:79], v18 offset:41984
    s_waitcnt lgkmcnt(7)
    v_mfma_f32_32x32x16_bf16 v[148:163], v[96:99], v[64:67], v[148:163]
    ds_read_b64_tr_b16 v[80:81], v19 offset:40960
    ds_read_b64_tr_b16 v[82:83], v19 offset:41984
    s_waitcnt lgkmcnt(6)
    v_mfma_f32_32x32x16_bf16 v[100:115], v[68:71], v[60:63], v[100:115]
    ds_read_b128 v[64:67], v15 offset:32768
    ds_read_b64_tr_b16 v[84:85], v16 offset:45056
    ds_read_b64_tr_b16 v[86:87], v16 offset:46080
    s_waitcnt lgkmcnt(7)
    v_mfma_f32_32x32x16_bf16 v[116:131], v[72:75], v[60:63], v[116:131]
    ds_read_b64_tr_b16 v[88:89], v17 offset:45056
    ds_read_b64_tr_b16 v[90:91], v17 offset:46080
    s_waitcnt lgkmcnt(7)
    v_mfma_f32_32x32x16_bf16 v[132:147], v[76:79], v[60:63], v[132:147]
    ds_read_b64_tr_b16 v[92:93], v18 offset:45056
    ds_read_b64_tr_b16 v[94:95], v18 offset:46080
    s_waitcnt lgkmcnt(7)
    v_mfma_f32_32x32x16_bf16 v[148:163], v[80:83], v[60:63], v[148:163]
    ds_read_b64_tr_b16 v[96:97], v19 offset:45056
    ds_read_b64_tr_b16 v[98:99], v19 offset:46080
    s_waitcnt lgkmcnt(0)
    s_barrier
    v_mfma_f32_32x32x16_bf16 v[100:115], v[84:87], v[64:67], v[100:115]
    s_add_u32 m0, s88, 0
    s_nop 0
    buffer_load_dwordx4 v32, s[48:51], s92 offen  lds
    v_mfma_f32_32x32x16_bf16 v[116:131], v[88:91], v[64:67], v[116:131]
    s_add_u32 m0, s88, 1024
    s_nop 0
    buffer_load_dwordx4 v33, s[48:51], s92 offen  lds
    v_mfma_f32_32x32x16_bf16 v[132:147], v[92:95], v[64:67], v[132:147]
    v_mfma_f32_32x32x16_bf16 v[148:163], v[96:99], v[64:67], v[148:163]
    s_nop 8
    v_cvt_pk_bf16_f32 v164, v100, v101
    v_cvt_pk_bf16_f32 v165, v102, v103
    v_cvt_pk_bf16_f32 v166, v104, v105
    v_cvt_pk_bf16_f32 v167, v106, v107
    v_cvt_pk_bf16_f32 v168, v108, v109
    v_cvt_pk_bf16_f32 v169, v110, v111
    v_cvt_pk_bf16_f32 v170, v112, v113
    v_cvt_pk_bf16_f32 v171, v114, v115
    v_mfma_f32_32x32x16_bf16 v[196:211], a[72:75], v[164:167], 0
    v_cvt_pk_bf16_f32 v172, v116, v117
    v_cvt_pk_bf16_f32 v173, v118, v119
    v_cvt_pk_bf16_f32 v174, v120, v121
    v_cvt_pk_bf16_f32 v175, v122, v123
    v_mfma_f32_32x32x16_bf16 v[196:211], a[76:79], v[168:171], v[196:211]
    s_add_u32 m0, s88, 2048
    s_nop 0
    buffer_load_dwordx4 v34, s[48:51], s92 offen  lds
    v_cvt_pk_bf16_f32 v176, v124, v125
    v_cvt_pk_bf16_f32 v177, v126, v127
    v_cvt_pk_bf16_f32 v178, v128, v129
    v_cvt_pk_bf16_f32 v179, v130, v131
    v_mfma_f32_32x32x16_bf16 v[196:211], a[80:83], v[172:175], v[196:211]
    v_cvt_pk_bf16_f32 v180, v132, v133
    v_cvt_pk_bf16_f32 v181, v134, v135
    v_cvt_pk_bf16_f32 v182, v136, v137
    v_cvt_pk_bf16_f32 v183, v138, v139
    v_mfma_f32_32x32x16_bf16 v[196:211], a[84:87], v[176:179], v[196:211]
    v_cvt_pk_bf16_f32 v184, v140, v141
    v_cvt_pk_bf16_f32 v185, v142, v143
    v_cvt_pk_bf16_f32 v186, v144, v145
    v_cvt_pk_bf16_f32 v187, v146, v147
    v_mfma_f32_32x32x16_bf16 v[196:211], a[88:91], v[180:183], v[196:211]
    s_add_u32 m0, s88, 3072
    s_nop 0
    buffer_load_dwordx4 v35, s[48:51], s92 offen  lds
    v_cvt_pk_bf16_f32 v188, v148, v149
    v_cvt_pk_bf16_f32 v189, v150, v151
    v_cvt_pk_bf16_f32 v190, v152, v153
    v_cvt_pk_bf16_f32 v191, v154, v155
    v_mfma_f32_32x32x16_bf16 v[196:211], a[92:95], v[184:187], v[196:211]
    v_cvt_pk_bf16_f32 v192, v156, v157
    v_cvt_pk_bf16_f32 v193, v158, v159
    v_cvt_pk_bf16_f32 v194, v160, v161
    v_cvt_pk_bf16_f32 v195, v162, v163
    v_mfma_f32_32x32x16_bf16 v[196:211], a[96:99], v[188:191], v[196:211]
    s_nop 1
    v_mfma_f32_32x32x16_bf16 v[196:211], a[100:103], v[192:195], v[196:211]
    s_add_u32 m0, s88, 4096
    s_nop 0
    buffer_load_dwordx4 v36, s[48:51], s92 offen  lds
    s_add_u32 m0, s88, 5120
    s_nop 0
    buffer_load_dwordx4 v37, s[48:51], s92 offen  lds
    s_nop 9
    v_max3_f32 v50, v196, v197, v198
    v_max3_f32 v51, v199, v200, v201
    s_add_u32 m0, s88, 6144
    s_nop 0
    buffer_load_dwordx4 v38, s[48:51], s92 offen  lds
    v_max3_f32 v52, v202, v203, v204
    v_max3_f32 v53, v205, v206, v207
    v_max3_f32 v50, v50, v208, v209
    v_max3_f32 v51, v51, v210, v211
    v_max_f32 v52, v52, v53
    v_max3_f32 v50, v50, v51, v52
    v_mov_b32 v51, v50
    s_nop 1
    v_permlane32_swap_b32 v50, v51
    s_nop 1
    v_max_f32 v50, v50, v51
    v_mul_f32 v50, s87, v50
    v_mov_b32 v52, s87
    v_mov_b32 v51, v50
    v_mov_b32 v53, s87
    v_pk_fma_f32 v[196:197], v[196:197], v[52:53], v[50:51] neg_lo:[0,0,1] neg_hi:[0,0,1]
    v_pk_fma_f32 v[198:199], v[198:199], v[52:53], v[50:51] neg_lo:[0,0,1] neg_hi:[0,0,1]
    v_pk_fma_f32 v[200:201], v[200:201], v[52:53], v[50:51] neg_lo:[0,0,1] neg_hi:[0,0,1]
    v_pk_fma_f32 v[202:203], v[202:203], v[52:53], v[50:51] neg_lo:[0,0,1] neg_hi:[0,0,1]
    v_pk_fma_f32 v[204:205], v[204:205], v[52:53], v[50:51] neg_lo:[0,0,1] neg_hi:[0,0,1]
    v_pk_fma_f32 v[206:207], v[206:207], v[52:53], v[50:51] neg_lo:[0,0,1] neg_hi:[0,0,1]
    v_pk_fma_f32 v[208:209], v[208:209], v[52:53], v[50:51] neg_lo:[0,0,1] neg_hi:[0,0,1]
    v_pk_fma_f32 v[210:211], v[210:211], v[52:53], v[50:51] neg_lo:[0,0,1] neg_hi:[0,0,1]
    v_exp_f32 v196, v196
    v_exp_f32 v197, v197
    v_exp_f32 v198, v198
    v_exp_f32 v199, v199
    v_exp_f32 v200, v200
    v_exp_f32 v201, v201
    v_pk_add_f32 v[50:51], v[196:197], v[198:199]
    s_add_u32 m0, s88, 7168
    s_nop 0
    buffer_load_dwordx4 v39, s[48:51], s92 offen  lds
    v_exp_f32 v202, v202
    v_exp_f32 v203, v203
    v_exp_f32 v204, v204
    v_exp_f32 v205, v205
    v_pk_add_f32 v[52:53], v[200:201], v[202:203]
    v_pk_add_f32 v[50:51], v[50:51], v[52:53]
    v_exp_f32 v206, v206
    v_exp_f32 v207, v207
    v_exp_f32 v208, v208
    v_exp_f32 v209, v209
    v_pk_add_f32 v[52:53], v[204:205], v[206:207]
    v_pk_add_f32 v[50:51], v[50:51], v[52:53]
    v_exp_f32 v210, v210
    v_exp_f32 v211, v211
    s_nop 0
    v_pk_add_f32 v[52:53], v[208:209], v[210:211]
    v_pk_add_f32 v[50:51], v[50:51], v[52:53]
    s_add_u32 m0, s88, 8192
    s_nop 0
    buffer_load_dwordx4 v40, s[48:51], s92 offen  lds
    v_add_f32 v50, v50, v51
    v_mov_b32 v51, v50
    s_nop 1
    v_permlane32_swap_b32 v50, v51
    s_nop 1
    v_add_f32 v50, v50, v51
    v_rcp_f32 v50, v50
    s_nop 0
    v_mov_b32 v51, v50
    v_pk_mul_f32 v[196:197], v[196:197], v[50:51]
    v_pk_mul_f32 v[198:199], v[198:199], v[50:51]
    v_pk_mul_f32 v[200:201], v[200:201], v[50:51]
    v_pk_mul_f32 v[202:203], v[202:203], v[50:51]
    v_pk_mul_f32 v[204:205], v[204:205], v[50:51]
    v_pk_mul_f32 v[206:207], v[206:207], v[50:51]
    v_pk_mul_f32 v[208:209], v[208:209], v[50:51]
    v_pk_mul_f32 v[210:211], v[210:211], v[50:51]
    v_cvt_pk_bf16_f32 v212, v196, v197
    v_cvt_pk_bf16_f32 v213, v198, v199
    v_cvt_pk_bf16_f32 v214, v200, v201
    v_cvt_pk_bf16_f32 v215, v202, v203
    v_cvt_pk_bf16_f32 v216, v204, v205
    v_cvt_pk_bf16_f32 v217, v206, v207
    v_cvt_pk_bf16_f32 v218, v208, v209
    v_cvt_pk_bf16_f32 v219, v210, v211
    s_nop 1
    buffer_store_dwordx4 v[212:215], v26, s[52:55], 0 offen offset:0 sc1
    buffer_store_dwordx4 v[216:219], v26, s[52:55], 0 offen offset:1024 sc1
    v_mfma_f32_32x32x16_bf16 v[100:115], a[104:107], v[212:215], 0
    v_mfma_f32_32x32x16_bf16 v[100:115], a[120:123], v[216:219], v[100:115]
    v_mfma_f32_32x32x16_bf16 v[116:131], a[108:111], v[212:215], 0
    v_mfma_f32_32x32x16_bf16 v[116:131], a[124:127], v[216:219], v[116:131]
    v_mfma_f32_32x32x16_bf16 v[132:147], a[112:115], v[212:215], 0
    s_nop 8
    v_cvt_pk_bf16_f32 v164, v100, v101
    v_cvt_pk_bf16_f32 v165, v102, v103
    v_cvt_pk_bf16_f32 v166, v104, v105
    v_cvt_pk_bf16_f32 v167, v106, v107
    v_cvt_pk_bf16_f32 v168, v108, v109
    v_cvt_pk_bf16_f32 v169, v110, v111
    v_cvt_pk_bf16_f32 v170, v112, v113
    v_cvt_pk_bf16_f32 v171, v114, v115
    v_mfma_f32_32x32x16_bf16 v[132:147], a[128:131], v[216:219], v[132:147]
    v_mfma_f32_32x32x16_bf16 v[148:163], a[116:119], v[212:215], 0
    v_cvt_pk_bf16_f32 v172, v116, v117
    v_cvt_pk_bf16_f32 v173, v118, v119
    v_cvt_pk_bf16_f32 v174, v120, v121
    v_cvt_pk_bf16_f32 v175, v122, v123
    v_cvt_pk_bf16_f32 v176, v124, v125
    v_cvt_pk_bf16_f32 v177, v126, v127
    v_cvt_pk_bf16_f32 v178, v128, v129
    v_cvt_pk_bf16_f32 v179, v130, v131
    v_mfma_f32_32x32x16_bf16 v[148:163], a[132:135], v[216:219], v[148:163]
    v_permlane16_swap_b32 v164, v168
    v_permlane16_swap_b32 v165, v169
    v_permlane16_swap_b32 v166, v170
    v_permlane16_swap_b32 v167, v171
    v_cvt_pk_bf16_f32 v180, v132, v133
    v_cvt_pk_bf16_f32 v181, v134, v135
    v_cvt_pk_bf16_f32 v182, v136, v137
    v_cvt_pk_bf16_f32 v183, v138, v139
    v_cvt_pk_bf16_f32 v184, v140, v141
    v_cvt_pk_bf16_f32 v185, v142, v143
    v_cvt_pk_bf16_f32 v186, v144, v145
    v_cvt_pk_bf16_f32 v187, v146, v147
    v_permlane16_swap_b32 v172, v176
    v_permlane16_swap_b32 v173, v177
    v_permlane16_swap_b32 v174, v178
    v_permlane16_swap_b32 v175, v179
    s_nop 0
    v_cvt_pk_bf16_f32 v188, v148, v149
    v_cvt_pk_bf16_f32 v189, v150, v151
    v_cvt_pk_bf16_f32 v190, v152, v153
    v_cvt_pk_bf16_f32 v191, v154, v155
    v_cvt_pk_bf16_f32 v192, v156, v157
    v_cvt_pk_bf16_f32 v193, v158, v159
    v_cvt_pk_bf16_f32 v194, v160, v161
    v_cvt_pk_bf16_f32 v195, v162, v163
    s_waitcnt vmcnt(0)
    v_mov_b32 v56, s29
    s_mov_b64 exec, 1
    buffer_store_dword v56, v27, s[52:55], 0 offen sc1
    s_mov_b64 exec, -1
    v_permlane16_swap_b32 v180, v184
    v_permlane16_swap_b32 v181, v185
    v_permlane16_swap_b32 v182, v186
    v_permlane16_swap_b32 v183, v187
    v_permlane16_swap_b32 v188, v192
    v_permlane16_swap_b32 v189, v193
    v_permlane16_swap_b32 v190, v194
    v_permlane16_swap_b32 v191, v195
    v_xor_b32 v20, 8192, v24
    s_mov_b32 m0, s97
    s_nop 0
    buffer_load_dwordx4 v20, s[44:47], 0 offen lds
    s_mov_b32 m0, s97
    s_nop 0
    buffer_load_dwordx4 v20, s[44:47], 0 offen offset:1024 lds
    s_mov_b32 m0, s97
    s_nop 0
    buffer_load_dwordx4 v20, s[44:47], 0 offen offset:2048 lds
    s_mov_b32 m0, s97
    s_nop 0
    buffer_load_dwordx4 v20, s[44:47], 0 offen offset:3072 lds
    s_barrier
    ds_read_b64_tr_b16 a[0:1], v41 offset:0
    ds_read_b64_tr_b16 a[2:3], v41 offset:4608
    ds_read_b64_tr_b16 a[4:5], v41 offset:32
    ds_read_b64_tr_b16 a[6:7], v41 offset:4640
    ds_read_b64_tr_b16 a[8:9], v41 offset:64
    ds_read_b64_tr_b16 a[10:11], v41 offset:4672
    ds_read_b64_tr_b16 a[12:13], v41 offset:96
    ds_read_b64_tr_b16 a[14:15], v41 offset:4704
    ds_read_b64_tr_b16 a[16:17], v41 offset:128
    ds_read_b64_tr_b16 a[18:19], v41 offset:4736
    ds_read_b64_tr_b16 a[20:21], v41 offset:160
    ds_read_b64_tr_b16 a[22:23], v41 offset:4768
    ds_read_b64_tr_b16 a[24:25], v41 offset:192
    ds_read_b64_tr_b16 a[26:27], v41 offset:4800
    ds_read_b64_tr_b16 a[28:29], v41 offset:224
    ds_read_b64_tr_b16 a[30:31], v41 offset:4832
    s_waitcnt lgkmcnt(12)
    v_mfma_f32_16x16x32_bf16 v[60:63], a[0:3], v[164:167], 0
    ds_read_b64_tr_b16 a[32:33], v41 offset:256
    s_add_u32 m0, s88, 36864
    s_nop 0
    buffer_load_dwordx4 v32, s[48:51], s93 offen  lds
    v_mfma_f32_16x16x32_bf16 v[96:99], a[0:3], v[168:171], 0
    ds_read_b64_tr_b16 a[34:35], v41 offset:4864
    v_mfma_f32_16x16x32_bf16 v[64:67], a[4:7], v[164:167], 0
    ds_read_b64_tr_b16 a[36:37], v41 offset:9216
    v_mfma_f32_16x16x32_bf16 v[100:103], a[4:7], v[168:171], 0
    ds_read_b64_tr_b16 a[38:39], v41 offset:13824
    s_waitcnt lgkmcnt(12)
    v_mfma_f32_16x16x32_bf16 v[68:71], a[8:11], v[164:167], 0
    ds_read_b64_tr_b16 a[40:41], v41 offset:9248
    s_add_u32 m0, s88, 37888
    s_nop 0
    buffer_load_dwordx4 v33, s[48:51], s93 offen  lds
    v_mfma_f32_16x16x32_bf16 v[104:107], a[8:11], v[168:171], 0
    ds_read_b64_tr_b16 a[42:43], v41 offset:13856
    v_mfma_f32_16x16x32_bf16 v[72:75], a[12:15], v[164:167], 0
    ds_read_b64_tr_b16 a[44:45], v41 offset:9280
    v_mfma_f32_16x16x32_bf16 v[108:111], a[12:15], v[168:171], 0
    ds_read_b64_tr_b16 a[46:47], v41 offset:13888
    s_waitcnt lgkmcnt(12)
    v_mfma_f32_16x16x32_bf16 v[76:79], a[16:19], v[164:167], 0
    ds_read_b64_tr_b16 a[48:49], v41 offset:9312
    s_add_u32 m0, s88, 38912
    s_nop 0
    buffer_load_dwordx4 v34, s[48:51], s93 offen  lds
    v_mfma_f32_16x16x32_bf16 v[112:115], a[16:19], v[168:171], 0
    ds_read_b64_tr_b16 a[50:51], v41 offset:13920
    v_mfma_f32_16x16x32_bf16 v[80:83], a[20:23], v[164:167], 0
    ds_read_b64_tr_b16 a[52:53], v41 offset:9344
    v_mfma_f32_16x16x32_bf16 v[116:119], a[20:23], v[168:171], 0
    ds_read_b64_tr_b16 a[54:55], v41 offset:13952
    s_waitcnt lgkmcnt(12)
    v_mfma_f32_16x16x32_bf16 v[84:87], a[24:27], v[164:167], 0
    ds_read_b64_tr_b16 a[56:57], v41 offset:9376
    s_add_u32 m0, s88, 39936
    s_nop 0
    buffer_load_dwordx4 v35, s[48:51], s93 offen  lds
    v_mfma_f32_16x16x32_bf16 v[120:123], a[24:27], v[168:171], 0
    ds_read_b64_tr_b16 a[58:59], v41 offset:13984
    v_mfma_f32_16x16x32_bf16 v[88:91], a[28:31], v[164:167], 0
    ds_read_b64_tr_b16 a[60:61], v41 offset:9408
    v_mfma_f32_16x16x32_bf16 v[124:127], a[28:31], v[168:171], 0
    ds_read_b64_tr_b16 a[62:63], v41 offset:14016
    s_waitcnt lgkmcnt(12)
    v_mfma_f32_16x16x32_bf16 v[92:95], a[32:35], v[164:167], 0
    ds_read_b64_tr_b16 a[0:1], v41 offset:9440
    s_add_u32 m0, s88, 40960
    s_nop 0
    buffer_load_dwordx4 v36, s[48:51], s93 offen  lds
    v_mfma_f32_16x16x32_bf16 v[128:131], a[32:35], v[168:171], 0
    ds_read_b64_tr_b16 a[2:3], v41 offset:14048
    v_mfma_f32_16x16x32_bf16 v[60:63], a[36:39], v[172:175], v[60:63]
    ds_read_b64_tr_b16 a[4:5], v41 offset:9472
    s_sub_u32 s78, s97, s85
    s_sub_u32 s78, s78, 8192
    v_add_u32 v28, s78, v28
    v_add_u32 v29, s78, v29
    v_add_u32 v30, s78, v30
    v_add_u32 v31, s78, v31
    s_waitcnt vmcnt(5)
    v_mfma_f32_16x16x32_bf16 v[96:99], a[36:39], v[176:179], v[96:99]
    ds_read_b64_tr_b16 a[6:7], v41 offset:14080
    ds_read_b64_tr_b16 a[136:137], v28 offset:0
    s_waitcnt lgkmcnt(13)
    v_mfma_f32_16x16x32_bf16 v[64:67], a[40:43], v[172:175], v[64:67]
    ds_read_b64_tr_b16 a[8:9], v41 offset:18432
    ds_read_b64_tr_b16 a[138:139], v28 offset:2048
    v_mfma_f32_16x16x32_bf16 v[100:103], a[40:43], v[176:179], v[100:103]
    ds_read_b64_tr_b16 a[10:11], v41 offset:23040
    ds_read_b64_tr_b16 a[140:141], v29 offset:0
    s_add_u32 m0, s88, 41984
    s_nop 0
    buffer_load_dwordx4 v37, s[48:51], s93 offen  lds
    v_mfma_f32_16x16x32_bf16 v[68:71], a[44:47], v[172:175], v[68:71]
    ds_read_b64_tr_b16 a[12:13], v41 offset:18464
    ds_read_b64_tr_b16 a[142:143], v29 offset:2048
    v_mfma_f32_16x16x32_bf16 v[104:107], a[44:47], v[176:179], v[104:107]
    ds_read_b64_tr_b16 a[14:15], v41 offset:23072
    ds_read_b64_tr_b16 a[144:145], v30 offset:0
    s_waitcnt lgkmcnt(15)
    v_mfma_f32_16x16x32_bf16 v[72:75], a[48:51], v[172:175], v[72:75]
    ds_read_b64_tr_b16 a[16:17], v41 offset:18496
    ds_read_b64_tr_b16 a[146:147], v30 offset:2048
    v_mfma_f32_16x16x32_bf16 v[108:111], a[48:51], v[176:179], v[108:111]
    ds_read_b64_tr_b16 a[18:19], v41 offset:23104
    ds_read_b64_tr_b16 a[148:149], v31 offset:0
    s_add_u32 m0, s88, 43008
    s_nop 0
    buffer_load_dwordx4 v38, s[48:51], s93 offen  lds
    v_mfma_f32_16x16x32_bf16 v[76:79], a[52:55], v[172:175], v[76:79]
    ds_read_b64_tr_b16 a[20:21], v41 offset:18528
    ds_read_b64_tr_b16 a[150:151], v31 offset:2048
    v_mfma_f32_16x16x32_bf16 v[112:115], a[52:55], v[176:179], v[112:115]
    ds_read_b64_tr_b16 a[22:23], v41 offset:23136
    s_waitcnt lgkmcnt(15)
    v_mfma_f32_16x16x32_bf16 v[80:83], a[56:59], v[172:175], v[80:83]
    ds_read_b64_tr_b16 a[24:25], v41 offset:18560
    v_mfma_f32_16x16x32_bf16 v[116:119], a[56:59], v[176:179], v[116:119]
    ds_read_b64_tr_b16 a[26:27], v41 offset:23168
    s_add_u32 m0, s88, 44032
    s_nop 0
    buffer_load_dwordx4 v39, s[48:51], s93 offen  lds
    v_mfma_f32_16x16x32_bf16 v[84:87], a[60:63], v[172:175], v[84:87]
    ds_read_b64_tr_b16 a[28:29], v41 offset:18592
    v_mfma_f32_16x16x32_bf16 v[120:123], a[60:63], v[176:179], v[120:123]
    ds_read_b64_tr_b16 a[30:31], v41 offset:23200
    v_mfma_f32_16x16x32_bf16 v[88:91], a[0:3], v[172:175], v[88:91]
    ds_read_b64_tr_b16 a[32:33], v41 offset:18624
    v_mfma_f32_16x16x32_bf16 v[124:127], a[0:3], v[176:179], v[124:127]
    ds_read_b64_tr_b16 a[34:35], v41 offset:23232
    s_add_u32 m0, s88, 45056
    s_nop 0
    buffer_load_dwordx4 v40, s[48:51], s93 offen  lds
    v_mfma_f32_16x16x32_bf16 v[92:95], a[4:7], v[172:175], v[92:95]
    ds_read_b64_tr_b16 a[36:37], v41 offset:18656
    v_mfma_f32_16x16x32_bf16 v[128:131], a[4:7], v[176:179], v[128:131]
    ds_read_b64_tr_b16 a[38:39], v41 offset:23264
    s_waitcnt lgkmcnt(15)
    v_mfma_f32_16x16x32_bf16 v[60:63], a[8:11], v[180:183], v[60:63]
    ds_read_b64_tr_b16 a[40:41], v41 offset:18688
    v_mfma_f32_16x16x32_bf16 v[96:99], a[8:11], v[184:187], v[96:99]
    ds_read_b64_tr_b16 a[42:43], v41 offset:23296
    v_mfma_f32_16x16x32_bf16 v[64:67], a[12:15], v[180:183], v[64:67]
    ds_read_b64_tr_b16 a[44:45], v41 offset:27648
    s_waitcnt lgkmcnt(12)
    s_mov_b32 m0, s97
    s_nop 0
    buffer_load_dwordx4 v20, s[44:47], s84 offen lds
    v_mfma_f32_16x16x32_bf16 v[100:103], a[12:15], v[184:187], v[100:103]
    ds_read_b64_tr_b16 a[46:47], v41 offset:32256
    s_waitcnt lgkmcnt(12)
    v_mfma_f32_16x16x32_bf16 v[68:71], a[16:19], v[180:183], v[68:71]
    ds_read_b64_tr_b16 a[48:49], v41 offset:27680
    s_mov_b32 m0, s97
    s_nop 0
    buffer_load_dwordx4 v20, s[44:47], s84 offen offset:1024 lds
    v_and_b32 v54, 3, v0
    v_lshl_add_u32 v54, v54, 7, s89
    buffer_load_dword v50, v54, s[52:55], 0 offen sc1
    v_mfma_f32_16x16x32_bf16 v[104:107], a[16:19], v[184:187], v[104:107]
    ds_read_b64_tr_b16 a[50:51], v41 offset:32288
    v_mfma_f32_16x16x32_bf16 v[72:75], a[20:23], v[180:183], v[72:75]
    ds_read_b64_tr_b16 a[52:53], v41 offset:27712
    s_mov_b32 m0, s97
    s_nop 0
    buffer_load_dwordx4 v20, s[44:47], s84 offen offset:2048 lds
    v_mfma_f32_16x16x32_bf16 v[108:111], a[20:23], v[184:187], v[108:111]
    ds_read_b64_tr_b16 a[54:55], v41 offset:32320
    s_waitcnt lgkmcnt(12)
    v_mfma_f32_16x16x32_bf16 v[76:79], a[24:27], v[180:183], v[76:79]
    ds_read_b64_tr_b16 a[56:57], v41 offset:27744
    s_mov_b32 m0, s97
    s_nop 0
    buffer_load_dwordx4 v20, s[44:47], s84 offen offset:3072 lds
    v_mfma_f32_16x16x32_bf16 v[112:115], a[24:27], v[184:187], v[112:115]
    ds_read_b64_tr_b16 a[58:59], v41 offset:32352
    v_mfma_f32_16x16x32_bf16 v[80:83], a[28:31], v[180:183], v[80:83]
    ds_read_b64_tr_b16 a[60:61], v41 offset:27776
    v_mfma_f32_16x16x32_bf16 v[116:119], a[28:31], v[184:187], v[116:119]
    ds_read_b64_tr_b16 a[62:63], v41 offset:32384
    s_waitcnt lgkmcnt(12)
    v_mfma_f32_16x16x32_bf16 v[84:87], a[32:35], v[180:183], v[84:87]
    ds_read_b64_tr_b16 a[0:1], v41 offset:27808
    v_mfma_f32_16x16x32_bf16 v[120:123], a[32:35], v[184:187], v[120:123]
    ds_read_b64_tr_b16 a[2:3], v41 offset:32416
    v_mfma_f32_16x16x32_bf16 v[88:91], a[36:39], v[180:183], v[88:91]
    ds_read_b64_tr_b16 a[4:5], v41 offset:27840
    v_mfma_f32_16x16x32_bf16 v[124:127], a[36:39], v[184:187], v[124:127]
    ds_read_b64_tr_b16 a[6:7], v41 offset:32448
    s_waitcnt lgkmcnt(12)
    v_mfma_f32_16x16x32_bf16 v[92:95], a[40:43], v[180:183], v[92:95]
    ds_read_b64_tr_b16 a[8:9], v41 offset:27872
    v_mfma_f32_16x16x32_bf16 v[128:131], a[40:43], v[184:187], v[128:131]
    ds_read_b64_tr_b16 a[10:11], v41 offset:32480
    s_waitcnt vmcnt(2)
    s_mov_b32 s90, 0
L_pv_5:
    v_cmp_ne_u32 vcc, s29, v50
    s_add_u32 s90, s90, 1
    s_cmp_lt_u32 s90, 524288
    s_nop 2
    s_cbranch_vccz L_pok_6
    s_cbranch_scc0 L_pok_6
    buffer_load_dword v50, v54, s[52:55], 0 offen sc1
    s_waitcnt vmcnt(0)
    s_branch L_pv_5
L_pok_6:
    buffer_load_dwordx4 a[72:75], v44, s[52:55], s33 offen offset:0 sc1
    buffer_load_dwordx4 a[76:79], v44, s[52:55], s33 offen offset:1024 sc1
    buffer_load_dwordx4 a[80:83], v44, s[52:55], s34 offen offset:0 sc1
    buffer_load_dwordx4 a[84:87], v44, s[52:55], s34 offen offset:1024 sc1
    buffer_load_dwordx4 a[88:91], v44, s[52:55], s35 offen offset:0 sc1
    buffer_load_dwordx4 a[92:95], v44, s[52:55], s35 offen offset:1024 sc1
    v_mfma_f32_16x16x32_bf16 v[60:63], a[44:47], v[188:191], v[60:63]
    ds_read_b64_tr_b16 a[12:13], v41 offset:27904
    s_add_u32 m0, s88, 73728
    s_nop 0
    buffer_load_dwordx4 v32, s[48:51], s94 offen  lds
    v_mfma_f32_16x16x32_bf16 v[96:99], a[44:47], v[192:195], v[96:99]
    ds_read_b64_tr_b16 a[14:15], v41 offset:32512
    s_waitcnt lgkmcnt(12)
    v_mfma_f32_16x16x32_bf16 v[64:67], a[48:51], v[188:191], v[64:67]
    s_barrier
    ds_read_b64_tr_b16 a[16:17], v41 offset:36864
    v_mfma_f32_16x16x32_bf16 v[100:103], a[48:51], v[192:195], v[100:103]
    ds_read_b64_tr_b16 a[18:19], v41 offset:41472
    s_waitcnt vmcnt(5)
    v_mfma_f32_32x32x16_bf16 v[228:243], a[104:107], a[72:75], 0
    s_add_u32 m0, s88, 74752
    s_nop 0
    buffer_load_dwordx4 v33, s[48:51], s94 offen  lds
    v_mfma_f32_16x16x32_bf16 v[68:71], a[52:55], v[188:191], v[68:71]
    ds_read_b64_tr_b16 a[20:21], v41 offset:36896
    v_mfma_f32_32x32x16_bf16 v[228:243], a[120:123], a[76:79], v[228:243]
    v_mfma_f32_16x16x32_bf16 v[104:107], a[52:55], v[192:195], v[104:107]
    ds_read_b64_tr_b16 a[22:23], v41 offset:41504
    v_mfma_f32_32x32x16_bf16 v[4:19], a[108:111], a[72:75], 0
    s_waitcnt lgkmcnt(12)
    v_mfma_f32_16x16x32_bf16 v[72:75], a[56:59], v[188:191], v[72:75]
    ds_read_b64_tr_b16 a[24:25], v41 offset:36928
    v_mfma_f32_32x32x16_bf16 v[4:19], a[124:127], a[76:79], v[4:19]
    s_add_u32 m0, s88, 75776
    s_nop 0
    buffer_load_dwordx4 v34, s[48:51], s94 offen  lds
    v_mfma_f32_16x16x32_bf16 v[108:111], a[56:59], v[192:195], v[108:111]
    ds_read_b64_tr_b16 a[26:27], v41 offset:41536
    v_mfma_f32_16x16x32_bf16 v[76:79], a[60:63], v[188:191], v[76:79]
    ds_read_b64_tr_b16 a[28:29], v41 offset:36960
    v_mfma_f32_16x16x32_bf16 v[112:115], a[60:63], v[192:195], v[112:115]
    ds_read_b64_tr_b16 a[30:31], v41 offset:41568
    s_add_u32 m0, s88, 76800
    s_nop 0
    buffer_load_dwordx4 v35, s[48:51], s94 offen  lds
    s_waitcnt lgkmcnt(12)
    v_mfma_f32_16x16x32_bf16 v[80:83], a[0:3], v[188:191], v[80:83]
    ds_read_b64_tr_b16 a[32:33], v41 offset:37120
    v_cvt_pk_bf16_f32 v132, v228, v229
    v_cvt_pk_bf16_f32 v133, v230, v231
    v_mfma_f32_16x16x32_bf16 v[116:119], a[0:3], v[192:195], v[116:119]
    ds_read_b64_tr_b16 a[34:35], v41 offset:41728
    v_cvt_pk_bf16_f32 v136, v236, v237
    v_cvt_pk_bf16_f32 v137, v238, v239
    v_mfma_f32_16x16x32_bf16 v[84:87], a[4:7], v[188:191], v[84:87]
    ds_read_b64_tr_b16 a[36:37], v41 offset:46080
    v_cvt_pk_bf16_f32 v134, v232, v233
    v_cvt_pk_bf16_f32 v135, v234, v235
    v_mfma_f32_16x16x32_bf16 v[120:123], a[4:7], v[192:195], v[120:123]
    ds_read_b64_tr_b16 a[38:39], v41 offset:50688
    v_cvt_pk_bf16_f32 v138, v240, v241
    v_cvt_pk_bf16_f32 v139, v242, v243
    s_add_u32 m0, s88, 77824
    s_nop 0
    buffer_load_dwordx4 v36, s[48:51], s94 offen  lds
    s_waitcnt lgkmcnt(12)
    v_mfma_f32_16x16x32_bf16 v[88:91], a[8:11], v[188:191], v[88:91]
    ds_read_b64_tr_b16 a[40:41], v41 offset:46112
    v_mfma_f32_16x16x32_bf16 v[124:127], a[8:11], v[192:195], v[124:127]
    ds_read_b64_tr_b16 a[42:43], v41 offset:50720
    v_permlane16_swap_b32 v132, v136
    v_permlane16_swap_b32 v133, v137
    v_mfma_f32_16x16x32_bf16 v[92:95], a[12:15], v[188:191], v[92:95]
    ds_read_b64_tr_b16 a[44:45], v41 offset:46144
    v_permlane16_swap_b32 v134, v138
    v_permlane16_swap_b32 v135, v139
    s_add_u32 m0, s88, 78848
    s_nop 0
    buffer_load_dwordx4 v37, s[48:51], s94 offen  lds
    v_mfma_f32_16x16x32_bf16 v[128:131], a[12:15], v[192:195], v[128:131]
    ds_read_b64_tr_b16 a[46:47], v41 offset:50752
    s_waitcnt lgkmcnt(12)
    v_mfma_f32_16x16x32_bf16 v[60:63], a[16:19], v[132:135], v[60:63]
    ds_read_b64_tr_b16 a[48:49], v41 offset:46176
    v_mfma_f32_32x32x16_bf16 v[228:243], a[112:115], a[72:75], 0
    v_add_u32 v57, 36864, v45
    v_lshlrev_b32 v55, 3, v0
    v_sub_u32 v58, v45, v55
    v_sub_u32 v59, v57, v55
    v_cvt_pk_bf16_f32 v140, v4, v5
    v_cvt_pk_bf16_f32 v141, v6, v7
    v_cvt_pk_bf16_f32 v144, v12, v13
    v_cvt_pk_bf16_f32 v145, v14, v15
    v_mfma_f32_16x16x32_bf16 v[96:99], a[16:19], v[136:139], v[96:99]
    ds_read_b64_tr_b16 a[50:51], v41 offset:50784
    v_mfma_f32_32x32x16_bf16 v[228:243], a[128:131], a[76:79], v[228:243]
    ds_read_b64_tr_b16 a[152:153], v28 offset:0
    v_cvt_pk_bf16_f32 v142, v8, v9
    v_cvt_pk_bf16_f32 v143, v10, v11
    v_cvt_pk_bf16_f32 v146, v16, v17
    v_cvt_pk_bf16_f32 v147, v18, v19
    s_add_u32 m0, s88, 79872
    s_nop 0
    buffer_load_dwordx4 v38, s[48:51], s94 offen  lds
    v_mfma_f32_16x16x32_bf16 v[64:67], a[20:23], v[132:135], v[64:67]
    ds_read_b64_tr_b16 a[52:53], v41 offset:46336
    ds_read_b64_tr_b16 a[154:155], v28 offset:2048
    v_permlane16_swap_b32 v140, v144
    v_permlane16_swap_b32 v141, v145
    v_mfma_f32_16x16x32_bf16 v[100:103], a[20:23], v[136:139], v[100:103]
    ds_read_b64_tr_b16 a[54:55], v41 offset:50944
    ds_read_b64_tr_b16 a[156:157], v29 offset:0
    s_waitcnt lgkmcnt(15)
    v_mfma_f32_16x16x32_bf16 v[68:71], a[24:27], v[132:135], v[68:71]
    ds_read_b64_tr_b16 a[56:57], v42 offset:0
    ds_read_b64_tr_b16 a[158:159], v29 offset:2048
    v_permlane16_swap_b32 v142, v146
    v_permlane16_swap_b32 v143, v147
    v_mfma_f32_16x16x32_bf16 v[104:107], a[24:27], v[136:139], v[104:107]
    ds_read_b64_tr_b16 a[58:59], v42 offset:4608
    ds_read_b64_tr_b16 a[160:161], v30 offset:0
    s_add_u32 m0, s88, 80896
    s_nop 0
    buffer_load_dwordx4 v39, s[48:51], s94 offen  lds
    v_mfma_f32_16x16x32_bf16 v[72:75], a[28:31], v[132:135], v[72:75]
    ds_read_b64_tr_b16 a[60:61], v42 offset:32
    ds_read_b64_tr_b16 a[162:163], v30 offset:2048
    v_mfma_f32_16x16x32_bf16 v[108:111], a[28:31], v[136:139], v[108:111]
    ds_read_b64_tr_b16 a[62:63], v42 offset:4640
    ds_read_b64_tr_b16 a[164:165], v31 offset:0
    s_waitcnt lgkmcnt(15)
    v_mfma_f32_16x16x32_bf16 v[92:95], a[32:35], v[132:135], v[92:95]
    ds_read_b64_tr_b16 a[0:1], v42 offset:64
    ds_read_b64_tr_b16 a[166:167], v31 offset:2048
    s_add_u32 m0, s88, 81920
    s_nop 0
    buffer_load_dwordx4 v40, s[48:51], s94 offen  lds
    v_mfma_f32_16x16x32_bf16 v[128:131], a[32:35], v[136:139], v[128:131]
    ds_read_b64_tr_b16 a[2:3], v42 offset:4672
    v_mfma_f32_16x16x32_bf16 v[60:63], a[36:39], v[140:143], v[60:63]
    ds_read_b64_tr_b16 a[4:5], v42 offset:96
    v_mfma_f32_32x32x16_bf16 v[4:19], a[116:119], a[72:75], 0
    v_cvt_pk_bf16_f32 v148, v228, v229
    v_cvt_pk_bf16_f32 v149, v230, v231
    v_cvt_pk_bf16_f32 v152, v236, v237
    v_cvt_pk_bf16_f32 v153, v238, v239
    s_add_u32 m0, s88, 110592
    s_nop 0
    buffer_load_dwordx4 v32, s[48:51], s95 offen  lds
    v_mfma_f32_16x16x32_bf16 v[96:99], a[36:39], v[144:147], v[96:99]
    ds_read_b64_tr_b16 a[6:7], v42 offset:4704
    v_mfma_f32_32x32x16_bf16 v[4:19], a[132:135], a[76:79], v[4:19]
    v_cvt_pk_bf16_f32 v150, v232, v233
    v_cvt_pk_bf16_f32 v151, v234, v235
    v_cvt_pk_bf16_f32 v154, v240, v241
    v_cvt_pk_bf16_f32 v155, v242, v243
    v_mfma_f32_16x16x32_bf16 v[64:67], a[40:43], v[140:143], v[64:67]
    ds_read_b64_tr_b16 a[8:9], v42 offset:256
    v_permlane16_swap_b32 v148, v152
    v_permlane16_swap_b32 v149, v153
    v_mfma_f32_16x16x32_bf16 v[100:103], a[40:43], v[144:147], v[100:103]
    ds_read_b64_tr_b16 a[10:11], v42 offset:4864
    s_add_u32 m0, s88, 111616
    s_nop 0
    buffer_load_dwordx4 v33, s[48:51], s95 offen  lds
    v_mfma_f32_16x16x32_bf16 v[68:71], a[44:47], v[140:143], v[68:71]
    ds_read_b64_tr_b16 a[12:13], v42 offset:9216
    v_permlane16_swap_b32 v150, v154
    v_permlane16_swap_b32 v151, v155
    v_mfma_f32_16x16x32_bf16 v[104:107], a[44:47], v[144:147], v[104:107]
    ds_read_b64_tr_b16 a[14:15], v42 offset:13824
    s_waitcnt lgkmcnt(15)
    v_mfma_f32_16x16x32_bf16 v[72:75], a[48:51], v[140:143], v[72:75]
    ds_read_b64_tr_b16 a[16:17], v42 offset:9248
    v_mfma_f32_16x16x32_bf16 v[108:111], a[48:51], v[144:147], v[108:111]
    ds_read_b64_tr_b16 a[18:19], v42 offset:13856
    s_add_u32 m0, s88, 112640
    s_nop 0
    buffer_load_dwordx4 v34, s[48:51], s95 offen  lds
    v_mfma_f32_16x16x32_bf16 v[92:95], a[52:55], v[140:143], v[92:95]
    ds_read_b64_tr_b16 a[20:21], v42 offset:9280
    v_mfma_f32_16x16x32_bf16 v[128:131], a[52:55], v[144:147], v[128:131]
    ds_read_b64_tr_b16 a[22:23], v42 offset:13888
    s_waitcnt lgkmcnt(14)
    v_mfma_f32_16x16x32_bf16 v[60:63], a[56:59], v[148:151], v[60:63]
    ds_read_b64_tr_b16 a[24:25], v42 offset:9312
    s_waitcnt vmcnt(14)
    s_waitcnt lgkmcnt(12)
    v_mfma_f32_32x32x16_bf16 v[228:243], a[136:139], a[80:83], 0
    v_cvt_pk_bf16_f32 v156, v4, v5
    v_cvt_pk_bf16_f32 v157, v6, v7
    v_cvt_pk_bf16_f32 v160, v12, v13
    v_cvt_pk_bf16_f32 v161, v14, v15
    s_add_u32 m0, s88, 113664
    s_nop 0
    buffer_load_dwordx4 v35, s[48:51], s95 offen  lds
    v_mfma_f32_16x16x32_bf16 v[96:99], a[56:59], v[152:155], v[96:99]
    ds_read_b64_tr_b16 a[26:27], v42 offset:13920
    v_mfma_f32_32x32x16_bf16 v[228:243], a[152:155], a[84:87], v[228:243]
    v_cvt_pk_bf16_f32 v158, v8, v9
    v_cvt_pk_bf16_f32 v159, v10, v11
    v_cvt_pk_bf16_f32 v162, v16, v17
    v_cvt_pk_bf16_f32 v163, v18, v19
    v_mfma_f32_16x16x32_bf16 v[64:67], a[60:63], v[148:151], v[64:67]
    ds_read_b64_tr_b16 a[28:29], v42 offset:9472
    v_permlane16_swap_b32 v156, v160
    v_permlane16_swap_b32 v157, v161
    v_mfma_f32_16x16x32_bf16 v[100:103], a[60:63], v[152:155], v[100:103]
    ds_read_b64_tr_b16 a[30:31], v42 offset:14080
    s_waitcnt lgkmcnt(12)
    v_mfma_f32_16x16x32_bf16 v[68:71], a[0:3], v[148:151], v[68:71]
    s_waitcnt vmcnt(4)
    s_barrier
    ds_read_b64_tr_b16 a[32:33], v42 offset:18432
    v_permlane16_swap_b32 v158, v162
    v_permlane16_swap_b32 v159, v163
    s_add_u32 m0, s88, 114688
    s_nop 0
    buffer_load_dwordx4 v36, s[48:51], s95 offen  lds
    v_mfma_f32_16x16x32_bf16 v[104:107], a[0:3], v[152:155], v[104:107]
    ds_read_b64_tr_b16 a[34:35], v42 offset:23040
    v_mfma_f32_16x16x32_bf16 v[72:75], a[4:7], v[148:151], v[72:75]
    ds_read_b64_tr_b16 a[36:37], v42 offset:18464
    v_mfma_f32_16x16x32_bf16 v[108:111], a[4:7], v[152:155], v[108:111]
    ds_read_b64_tr_b16 a[38:39], v42 offset:23072
    s_add_u32 m0, s88, 115712
    s_nop 0
    buffer_load_dwordx4 v37, s[48:51], s95 offen  lds
    s_waitcnt lgkmcnt(12)
    v_mfma_f32_16x16x32_bf16 v[92:95], a[8:11], v[148:151], v[92:95]
    ds_read_b64_tr_b16 a[40:41], v42 offset:18496
    v_mfma_f32_16x16x32_bf16 v[128:131], a[8:11], v[152:155], v[128:131]
    ds_read_b64_tr_b16 a[42:43], v42 offset:23104
    v_mfma_f32_16x16x32_bf16 v[60:63], a[12:15], v[156:159], v[60:63]
    ds_read_b64_tr_b16 a[44:45], v42 offset:18528
    v_mfma_f32_32x32x16_bf16 v[4:19], a[140:143], a[80:83], 0
    v_cvt_pk_bf16_f32 v196, v228, v229
    v_cvt_pk_bf16_f32 v197, v230, v231
    v_cvt_pk_bf16_f32 v200, v236, v237
    v_cvt_pk_bf16_f32 v201, v238, v239
    v_mfma_f32_16x16x32_bf16 v[96:99], a[12:15], v[160:163], v[96:99]
    ds_read_b64_tr_b16 a[46:47], v42 offset:23136
    v_mfma_f32_32x32x16_bf16 v[4:19], a[156:159], a[84:87], v[4:19]
    v_cvt_pk_bf16_f32 v198, v232, v233
    v_cvt_pk_bf16_f32 v199, v234, v235
    v_cvt_pk_bf16_f32 v202, v240, v241
    v_cvt_pk_bf16_f32 v203, v242, v243
    s_add_u32 m0, s88, 116736
    s_nop 0
    buffer_load_dwordx4 v38, s[48:51], s95 offen  lds
    s_waitcnt lgkmcnt(12)
    v_mfma_f32_16x16x32_bf16 v[64:67], a[16:19], v[156:159], v[64:67]
    ds_read_b64_tr_b16 a[48:49], v42 offset:18688
    v_permlane16_swap_b32 v196, v200
    v_permlane16_swap_b32 v197, v201
    v_mfma_f32_16x16x32_bf16 v[100:103], a[16:19], v[160:163], v[100:103]
    ds_read_b64_tr_b16 a[50:51], v42 offset:23296
    v_mfma_f32_16x16x32_bf16 v[68:71], a[20:23], v[156:159], v[68:71]
    ds_read_b64_tr_b16 a[52:53], v42 offset:27648
    v_permlane16_swap_b32 v198, v202
    v_permlane16_swap_b32 v199, v203
    s_add_u32 m0, s88, 117760
    s_nop 0
    buffer_load_dwordx4 v39, s[48:51], s95 offen  lds
    v_mfma_f32_16x16x32_bf16 v[104:107], a[20:23], v[160:163], v[104:107]
    ds_read_b64_tr_b16 a[54:55], v42 offset:32256
    s_waitcnt lgkmcnt(12)
    v_mfma_f32_16x16x32_bf16 v[72:75], a[24:27], v[156:159], v[72:75]
    ds_read_b64_tr_b16 a[56:57], v42 offset:27680
    v_mfma_f32_16x16x32_bf16 v[108:111], a[24:27], v[160:163], v[108:111]
    ds_read_b64_tr_b16 a[58:59], v42 offset:32288
    v_mfma_f32_16x16x32_bf16 v[92:95], a[28:31], v[156:159], v[92:95]
    ds_read_b64_tr_b16 a[60:61], v42 offset:27712
    s_add_u32 m0, s88, 118784
    s_nop 0
    buffer_load_dwordx4 v40, s[48:51], s95 offen  lds
    v_mfma_f32_16x16x32_bf16 v[128:131], a[28:31], v[160:163], v[128:131]
    ds_read_b64_tr_b16 a[62:63], v42 offset:32320
    s_waitcnt lgkmcnt(12)
    v_mfma_f32_16x16x32_bf16 v[60:63], a[32:35], v[196:199], v[60:63]
    ds_read_b64_tr_b16 a[0:1], v42 offset:27744
    v_mfma_f32_32x32x16_bf16 v[228:243], a[144:147], a[80:83], 0
    v_cvt_pk_bf16_f32 v204, v4, v5
    v_cvt_pk_bf16_f32 v205, v6, v7
    v_cvt_pk_bf16_f32 v208, v12, v13
    v_cvt_pk_bf16_f32 v209, v14, v15
    v_mfma_f32_16x16x32_bf16 v[96:99], a[32:35], v[200:203], v[96:99]
    ds_read_b64_tr_b16 a[2:3], v42 offset:32352
    v_mfma_f32_32x32x16_bf16 v[228:243], a[160:163], a[84:87], v[228:243]
    v_cvt_pk_bf16_f32 v206, v8, v9
    v_cvt_pk_bf16_f32 v207, v10, v11
    v_cvt_pk_bf16_f32 v210, v16, v17
    v_cvt_pk_bf16_f32 v211, v18, v19
    v_mfma_f32_16x16x32_bf16 v[64:67], a[36:39], v[196:199], v[64:67]
    ds_read_b64_tr_b16 a[4:5], v42 offset:27904
    v_permlane16_swap_b32 v204, v208
    v_permlane16_swap_b32 v205, v209
    v_mfma_f32_16x16x32_bf16 v[100:103], a[36:39], v[200:203], v[100:103]
    ds_read_b64_tr_b16 a[6:7], v42 offset:32512
    s_waitcnt lgkmcnt(12)
    v_mfma_f32_16x16x32_bf16 v[68:71], a[40:43], v[196:199], v[68:71]
    ds_read_b64_tr_b16 a[8:9], v42 offset:36864
    v_permlane16_swap_b32 v206, v210
    v_permlane16_swap_b32 v207, v211
    v_mfma_f32_16x16x32_bf16 v[104:107], a[40:43], v[200:203], v[104:107]
    ds_read_b64_tr_b16 a[10:11], v42 offset:41472
    v_mfma_f32_16x16x32_bf16 v[72:75], a[44:47], v[196:199], v[72:75]
    ds_read_b64_tr_b16 a[12:13], v42 offset:36896
    v_mfma_f32_16x16x32_bf16 v[108:111], a[44:47], v[200:203], v[108:111]
    ds_read_b64_tr_b16 a[14:15], v42 offset:41504
    s_waitcnt lgkmcnt(12)
    v_mfma_f32_16x16x32_bf16 v[92:95], a[48:51], v[196:199], v[92:95]
    ds_read_b64_tr_b16 a[16:17], v42 offset:36928
    v_mfma_f32_16x16x32_bf16 v[128:131], a[48:51], v[200:203], v[128:131]
    ds_read_b64_tr_b16 a[18:19], v42 offset:41536
    v_mfma_f32_16x16x32_bf16 v[60:63], a[52:55], v[204:207], v[60:63]
    ds_read_b64_tr_b16 a[20:21], v42 offset:36960
    v_mfma_f32_32x32x16_bf16 v[4:19], a[148:151], a[80:83], 0
    v_cvt_pk_bf16_f32 v212, v228, v229
    v_cvt_pk_bf16_f32 v213, v230, v231
    v_cvt_pk_bf16_f32 v216, v236, v237
    v_cvt_pk_bf16_f32 v217, v238, v239
    v_mfma_f32_16x16x32_bf16 v[96:99], a[52:55], v[208:211], v[96:99]
    ds_read_b64_tr_b16 a[22:23], v42 offset:41568
    v_mfma_f32_32x32x16_bf16 v[4:19], a[164:167], a[84:87], v[4:19]
    v_cvt_pk_bf16_f32 v214, v232, v233
    v_cvt_pk_bf16_f32 v215, v234, v235
    v_cvt_pk_bf16_f32 v218, v240, v241
    v_cvt_pk_bf16_f32 v219, v242, v243
    s_waitcnt lgkmcnt(12)
    v_mfma_f32_16x16x32_bf16 v[64:67], a[56:59], v[204:207], v[64:67]
    ds_read_b64_tr_b16 a[24:25], v42 offset:37120
    v_permlane16_swap_b32 v212, v216
    v_permlane16_swap_b32 v213, v217
    v_mfma_f32_16x16x32_bf16 v[100:103], a[56:59], v[208:211], v[100:103]
    ds_read_b64_tr_b16 a[26:27], v42 offset:41728
    v_mfma_f32_16x16x32_bf16 v[68:71], a[60:63], v[204:207], v[68:71]
    ds_read_b64_tr_b16 a[28:29], v42 offset:46080
    v_permlane16_swap_b32 v214, v218
    v_permlane16_swap_b32 v215, v219
    v_mfma_f32_16x16x32_bf16 v[104:107], a[60:63], v[208:211], v[104:107]
    ds_read_b64_tr_b16 a[30:31], v42 offset:50688
    s_waitcnt lgkmcnt(12)
    v_mfma_f32_16x16x32_bf16 v[72:75], a[0:3], v[204:207], v[72:75]
    ds_read_b64_tr_b16 a[32:33], v42 offset:46112
    v_mfma_f32_16x16x32_bf16 v[108:111], a[0:3], v[208:211], v[108:111]
    ds_read_b64_tr_b16 a[34:35], v42 offset:50720
    v_mfma_f32_16x16x32_bf16 v[92:95], a[4:7], v[204:207], v[92:95]
    ds_read_b64_tr_b16 a[36:37], v42 offset:46144
    v_mfma_f32_16x16x32_bf16 v[128:131], a[4:7], v[208:211], v[128:131]
    ds_read_b64_tr_b16 a[38:39], v42 offset:50752
    s_waitcnt lgkmcnt(12)
    v_mfma_f32_16x16x32_bf16 v[60:63], a[8:11], v[212:215], v[60:63]
    ds_read_b64_tr_b16 a[40:41], v42 offset:46176
    v_mfma_f32_32x32x16_bf16 v[228:243], a[136:139], a[88:91], 0
    v_cvt_pk_bf16_f32 v220, v4, v5
    v_cvt_pk_bf16_f32 v221, v6, v7
    v_cvt_pk_bf16_f32 v224, v12, v13
    v_cvt_pk_bf16_f32 v225, v14, v15
    v_mfma_f32_16x16x32_bf16 v[96:99], a[8:11], v[216:219], v[96:99]
    ds_read_b64_tr_b16 a[42:43], v42 offset:50784
    v_mfma_f32_32x32x16_bf16 v[228:243], a[152:155], a[92:95], v[228:243]
    v_cvt_pk_bf16_f32 v222, v8, v9
    v_cvt_pk_bf16_f32 v223, v10, v11
    v_cvt_pk_bf16_f32 v226, v16, v17
    v_cvt_pk_bf16_f32 v227, v18, v19
    v_mfma_f32_16x16x32_bf16 v[64:67], a[12:15], v[212:215], v[64:67]
    ds_read_b64_tr_b16 a[44:45], v42 offset:46336
    v_permlane16_swap_b32 v220, v224
    v_permlane16_swap_b32 v221, v225
    v_mfma_f32_16x16x32_bf16 v[100:103], a[12:15], v[216:219], v[100:103]
    ds_read_b64_tr_b16 a[46:47], v42 offset:50944
    s_waitcnt lgkmcnt(12)
    v_mfma_f32_16x16x32_bf16 v[68:71], a[16:19], v[212:215], v[68:71]
    s_waitcnt vmcnt(0)
    s_barrier
    ds_read_b64_tr_b16 a[48:49], v43 offset:0
    v_permlane16_swap_b32 v222, v226
    v_permlane16_swap_b32 v223, v227
    v_mfma_f32_16x16x32_bf16 v[104:107], a[16:19], v[216:219], v[104:107]
    ds_read_b64_tr_b16 a[50:51], v43 offset:4608
    v_mfma_f32_16x16x32_bf16 v[72:75], a[20:23], v[212:215], v[72:75]
    ds_read_b64_tr_b16 a[52:53], v43 offset:32
    v_mfma_f32_16x16x32_bf16 v[108:111], a[20:23], v[216:219], v[108:111]
    ds_read_b64_tr_b16 a[54:55], v43 offset:4640
    s_waitcnt lgkmcnt(12)
    v_mfma_f32_16x16x32_bf16 v[92:95], a[24:27], v[212:215], v[92:95]
    ds_read_b64_tr_b16 a[56:57], v43 offset:64
    v_mfma_f32_16x16x32_bf16 v[128:131], a[24:27], v[216:219], v[128:131]
    ds_read_b64_tr_b16 a[58:59], v43 offset:4672
    v_mfma_f32_16x16x32_bf16 v[60:63], a[28:31], v[220:223], v[60:63]
    ds_read_b64_tr_b16 a[60:61], v43 offset:96
    v_mfma_f32_32x32x16_bf16 v[4:19], a[140:143], a[88:91], 0
    v_cvt_pk_bf16_f32 v164, v228, v229
    v_cvt_pk_bf16_f32 v165, v230, v231
    v_cvt_pk_bf16_f32 v168, v236, v237
    v_cvt_pk_bf16_f32 v169, v238, v239
    v_mfma_f32_16x16x32_bf16 v[96:99], a[28:31], v[224:227], v[96:99]
    ds_read_b64_tr_b16 a[62:63], v43 offset:4704
    v_mfma_f32_32x32x16_bf16 v[4:19], a[156:159], a[92:95], v[4:19]
    v_cvt_pk_bf16_f32 v166, v232, v233
    v_cvt_pk_bf16_f32 v167, v234, v235
    v_cvt_pk_bf16_f32 v170, v240, v241
    v_cvt_pk_bf16_f32 v171, v242, v243
    s_waitcnt lgkmcnt(12)
    v_mfma_f32_16x16x32_bf16 v[64:67], a[32:35], v[220:223], v[64:67]
    ds_read_b64_tr_b16 a[0:1], v43 offset:256
    v_permlane16_swap_b32 v164, v168
    v_permlane16_swap_b32 v165, v169
    v_mfma_f32_16x16x32_bf16 v[100:103], a[32:35], v[224:227], v[100:103]
    ds_read_b64_tr_b16 a[2:3], v43 offset:4864
    v_mfma_f32_16x16x32_bf16 v[68:71], a[36:39], v[220:223], v[68:71]
    ds_read_b64_tr_b16 a[4:5], v43 offset:9216
    v_permlane16_swap_b32 v166, v170
    v_permlane16_swap_b32 v167, v171
    v_mfma_f32_16x16x32_bf16 v[104:107], a[36:39], v[224:227], v[104:107]
    ds_read_b64_tr_b16 a[6:7], v43 offset:13824
    s_waitcnt lgkmcnt(12)
    v_mfma_f32_16x16x32_bf16 v[72:75], a[40:43], v[220:223], v[72:75]
    ds_read_b64_tr_b16 a[8:9], v43 offset:9248
    v_mfma_f32_16x16x32_bf16 v[108:111], a[40:43], v[224:227], v[108:111]
    ds_read_b64_tr_b16 a[10:11], v43 offset:13856
    v_mfma_f32_16x16x32_bf16 v[92:95], a[44:47], v[220:223], v[92:95]
    ds_read_b64_tr_b16 a[12:13], v43 offset:9280
    v_mfma_f32_16x16x32_bf16 v[128:131], a[44:47], v[224:227], v[128:131]
    ds_read_b64_tr_b16 a[14:15], v43 offset:13888
    s_waitcnt lgkmcnt(12)
    v_mfma_f32_16x16x32_bf16 v[60:63], a[48:51], v[164:167], v[60:63]
    ds_read_b64_tr_b16 a[16:17], v43 offset:9312
    v_mfma_f32_32x32x16_bf16 v[228:243], a[144:147], a[88:91], 0
    v_cvt_pk_bf16_f32 v172, v4, v5
    v_cvt_pk_bf16_f32 v173, v6, v7
    v_cvt_pk_bf16_f32 v176, v12, v13
    v_cvt_pk_bf16_f32 v177, v14, v15
    v_mfma_f32_16x16x32_bf16 v[96:99], a[48:51], v[168:171], v[96:99]
    ds_read_b64_tr_b16 a[18:19], v43 offset:13920
    v_mfma_f32_32x32x16_bf16 v[228:243], a[160:163], a[92:95], v[228:243]
    v_cvt_pk_bf16_f32 v174, v8, v9
    v_cvt_pk_bf16_f32 v175, v10, v11
    v_cvt_pk_bf16_f32 v178, v16, v17
    v_cvt_pk_bf16_f32 v179, v18, v19
    v_mfma_f32_16x16x32_bf16 v[64:67], a[52:55], v[164:167], v[64:67]
    ds_read_b64_tr_b16 a[20:21], v43 offset:9472
    v_permlane16_swap_b32 v172, v176
    v_permlane16_swap_b32 v173, v177
    v_mfma_f32_16x16x32_bf16 v[100:103], a[52:55], v[168:171], v[100:103]
    ds_read_b64_tr_b16 a[22:23], v43 offset:14080
    s_waitcnt lgkmcnt(12)
    v_mfma_f32_16x16x32_bf16 v[68:71], a[56:59], v[164:167], v[68:71]
    ds_read_b64_tr_b16 a[24:25], v43 offset:18432
    v_permlane16_swap_b32 v174, v178
    v_permlane16_swap_b32 v175, v179
    v_mfma_f32_16x16x32_bf16 v[104:107], a[56:59], v[168:171], v[104:107]
    ds_read_b64_tr_b16 a[26:27], v43 offset:23040
    v_mfma_f32_16x16x32_bf16 v[72:75], a[60:63], v[164:167], v[72:75]
    ds_read_b64_tr_b16 a[28:29], v43 offset:18464
    v_mfma_f32_16x16x32_bf16 v[108:111], a[60:63], v[168:171], v[108:111]
    ds_read_b64_tr_b16 a[30:31], v43 offset:23072
    s_waitcnt lgkmcnt(12)
    v_mfma_f32_16x16x32_bf16 v[92:95], a[0:3], v[164:167], v[92:95]
    ds_read_b64_tr_b16 a[32:33], v43 offset:18496
    v_mfma_f32_16x16x32_bf16 v[128:131], a[0:3], v[168:171], v[128:131]
    ds_read_b64_tr_b16 a[34:35], v43 offset:23104
    v_mfma_f32_16x16x32_bf16 v[60:63], a[4:7], v[172:175], v[60:63]
    ds_read_b64_tr_b16 a[36:37], v43 offset:18528
    v_mfma_f32_32x32x16_bf16 v[4:19], a[148:151], a[88:91], 0
    v_cvt_pk_bf16_f32 v180, v228, v229
    v_cvt_pk_bf16_f32 v181, v230, v231
    v_cvt_pk_bf16_f32 v184, v236, v237
    v_cvt_pk_bf16_f32 v185, v238, v239
    v_mfma_f32_16x16x32_bf16 v[96:99], a[4:7], v[176:179], v[96:99]
    ds_read_b64_tr_b16 a[38:39], v43 offset:23136
    v_mfma_f32_32x32x16_bf16 v[4:19], a[164:167], a[92:95], v[4:19]
    v_cvt_pk_bf16_f32 v182, v232, v233
    v_cvt_pk_bf16_f32 v183, v234, v235
    v_cvt_pk_bf16_f32 v186, v240, v241
    v_cvt_pk_bf16_f32 v187, v242, v243
    s_waitcnt lgkmcnt(12)
    v_mfma_f32_16x16x32_bf16 v[64:67], a[8:11], v[172:175], v[64:67]
    ds_read_b64_tr_b16 a[40:41], v43 offset:18688
    v_permlane16_swap_b32 v180, v184
    v_permlane16_swap_b32 v181, v185
    v_mfma_f32_16x16x32_bf16 v[100:103], a[8:11], v[176:179], v[100:103]
    ds_read_b64_tr_b16 a[42:43], v43 offset:23296
    v_mfma_f32_16x16x32_bf16 v[68:71], a[12:15], v[172:175], v[68:71]
    ds_read_b64_tr_b16 a[44:45], v43 offset:27648
    v_permlane16_swap_b32 v182, v186
    v_permlane16_swap_b32 v183, v187
    v_mfma_f32_16x16x32_bf16 v[104:107], a[12:15], v[176:179], v[104:107]
    ds_read_b64_tr_b16 a[46:47], v43 offset:32256
    s_waitcnt lgkmcnt(12)
    v_mfma_f32_16x16x32_bf16 v[72:75], a[16:19], v[172:175], v[72:75]
    ds_read_b64_tr_b16 a[48:49], v43 offset:27680
    v_mfma_f32_16x16x32_bf16 v[108:111], a[16:19], v[176:179], v[108:111]
    ds_read_b64_tr_b16 a[50:51], v43 offset:32288
    v_mfma_f32_16x16x32_bf16 v[92:95], a[20:23], v[172:175], v[92:95]
    ds_read_b64_tr_b16 a[52:53], v43 offset:27712
    v_mfma_f32_16x16x32_bf16 v[128:131], a[20:23], v[176:179], v[128:131]
    ds_read_b64_tr_b16 a[54:55], v43 offset:32320
    s_waitcnt lgkmcnt(12)
    v_mfma_f32_16x16x32_bf16 v[60:63], a[24:27], v[180:183], v[60:63]
    ds_read_b64_tr_b16 a[56:57], v43 offset:27744
    v_cvt_pk_bf16_f32 v188, v4, v5
    v_cvt_pk_bf16_f32 v189, v6, v7
    v_cvt_pk_bf16_f32 v192, v12, v13
    v_cvt_pk_bf16_f32 v193, v14, v15
    v_mfma_f32_16x16x32_bf16 v[96:99], a[24:27], v[184:187], v[96:99]
    ds_read_b64_tr_b16 a[58:59], v43 offset:32352
    v_cvt_pk_bf16_f32 v190, v8, v9
    v_cvt_pk_bf16_f32 v191, v10, v11
    v_cvt_pk_bf16_f32 v194, v16, v17
    v_cvt_pk_bf16_f32 v195, v18, v19
    v_mfma_f32_16x16x32_bf16 v[64:67], a[28:31], v[180:183], v[64:67]
    ds_read_b64_tr_b16 a[60:61], v43 offset:27904
    v_permlane16_swap_b32 v188, v192
    v_permlane16_swap_b32 v189, v193
    v_mfma_f32_16x16x32_bf16 v[100:103], a[28:31], v[184:187], v[100:103]
    ds_read_b64_tr_b16 a[62:63], v43 offset:32512
    s_waitcnt lgkmcnt(12)
    v_mfma_f32_16x16x32_bf16 v[68:71], a[32:35], v[180:183], v[68:71]
    ds_read_b64_tr_b16 a[0:1], v41 offset:36992
    v_permlane16_swap_b32 v190, v194
    v_permlane16_swap_b32 v191, v195
    v_mfma_f32_16x16x32_bf16 v[104:107], a[32:35], v[184:187], v[104:107]
    ds_read_b64_tr_b16 a[2:3], v41 offset:41600
    v_mfma_f32_16x16x32_bf16 v[72:75], a[36:39], v[180:183], v[72:75]
    ds_read_b64_tr_b16 a[4:5], v41 offset:37024
    v_mfma_f32_16x16x32_bf16 v[108:111], a[36:39], v[184:187], v[108:111]
    ds_read_b64_tr_b16 a[6:7], v41 offset:41632
    s_waitcnt lgkmcnt(12)
    v_mfma_f32_16x16x32_bf16 v[92:95], a[40:43], v[180:183], v[92:95]
    ds_read_b64_tr_b16 a[8:9], v41 offset:37056
    v_mfma_f32_16x16x32_bf16 v[128:131], a[40:43], v[184:187], v[128:131]
    ds_read_b64_tr_b16 a[10:11], v41 offset:41664
    v_mfma_f32_16x16x32_bf16 v[60:63], a[44:47], v[188:191], v[60:63]
    ds_read_b64_tr_b16 a[12:13], v41 offset:37088
    v_mfma_f32_16x16x32_bf16 v[96:99], a[44:47], v[192:195], v[96:99]
    ds_read_b64_tr_b16 a[14:15], v41 offset:41696
    s_waitcnt lgkmcnt(12)
    v_mfma_f32_16x16x32_bf16 v[64:67], a[48:51], v[188:191], v[64:67]
    ds_read_b64_tr_b16 a[16:17], v41 offset:46208
    v_mfma_f32_16x16x32_bf16 v[100:103], a[48:51], v[192:195], v[100:103]
    ds_read_b64_tr_b16 a[18:19], v41 offset:50816
    v_mfma_f32_16x16x32_bf16 v[68:71], a[52:55], v[188:191], v[68:71]
    ds_read_b64_tr_b16 a[20:21], v41 offset:46240
    v_mfma_f32_16x16x32_bf16 v[104:107], a[52:55], v[192:195], v[104:107]
    ds_read_b64_tr_b16 a[22:23], v41 offset:50848
    s_waitcnt lgkmcnt(12)
    v_mfma_f32_16x16x32_bf16 v[72:75], a[56:59], v[188:191], v[72:75]
    ds_read_b64_tr_b16 a[24:25], v41 offset:46272
    v_mfma_f32_16x16x32_bf16 v[108:111], a[56:59], v[192:195], v[108:111]
    ds_read_b64_tr_b16 a[26:27], v41 offset:50880
    v_mfma_f32_16x16x32_bf16 v[92:95], a[60:63], v[188:191], v[92:95]
    ds_read_b64_tr_b16 a[28:29], v41 offset:46304
    v_mfma_f32_16x16x32_bf16 v[128:131], a[60:63], v[192:195], v[128:131]
    ds_read_b64_tr_b16 a[30:31], v41 offset:50912
    s_waitcnt lgkmcnt(12)
    v_mfma_f32_16x16x32_bf16 v[76:79], a[0:3], v[132:135], v[76:79]
    ds_read_b64_tr_b16 a[32:33], v42 offset:128
    v_cvt_pk_bf16_f32 v228, v60, v61
    v_cvt_pk_bf16_f32 v229, v62, v63
    v_mfma_f32_16x16x32_bf16 v[112:115], a[0:3], v[136:139], v[112:115]
    ds_read_b64_tr_b16 a[34:35], v42 offset:4736
    v_cvt_pk_bf16_f32 v230, v64, v65
    v_mfma_f32_16x16x32_bf16 v[80:83], a[4:7], v[132:135], v[80:83]
    ds_read_b64_tr_b16 a[36:37], v42 offset:160
    v_cvt_pk_bf16_f32 v231, v66, v67
    v_mfma_f32_16x16x32_bf16 v[116:119], a[4:7], v[136:139], v[116:119]
    ds_read_b64_tr_b16 a[38:39], v42 offset:4768
    buffer_store_dwordx4 v[228:231], v45, s[52:55], 0 offen offset:0 sc1
    s_waitcnt lgkmcnt(12)
    v_mfma_f32_16x16x32_bf16 v[84:87], a[8:11], v[132:135], v[84:87]
    ds_read_b64_tr_b16 a[40:41], v42 offset:192
    v_cvt_pk_bf16_f32 v232, v68, v69
    v_mfma_f32_16x16x32_bf16 v[120:123], a[8:11], v[136:139], v[120:123]
    ds_read_b64_tr_b16 a[42:43], v42 offset:4800
    v_cvt_pk_bf16_f32 v233, v70, v71
    v_mfma_f32_16x16x32_bf16 v[88:91], a[12:15], v[132:135], v[88:91]
    ds_read_b64_tr_b16 a[44:45], v42 offset:224
    v_cvt_pk_bf16_f32 v234, v72, v73
    v_mfma_f32_16x16x32_bf16 v[124:127], a[12:15], v[136:139], v[124:127]
    ds_read_b64_tr_b16 a[46:47], v42 offset:4832
    v_cvt_pk_bf16_f32 v235, v74, v75
    s_waitcnt lgkmcnt(12)
    v_mfma_f32_16x16x32_bf16 v[76:79], a[16:19], v[140:143], v[76:79]
    ds_read_b64_tr_b16 a[48:49], v42 offset:9344
    buffer_store_dwordx4 v[232:235], v45, s[52:55], 0 offen offset:1024 sc1
    v_mfma_f32_16x16x32_bf16 v[112:115], a[16:19], v[144:147], v[112:115]
    ds_read_b64_tr_b16 a[50:51], v42 offset:13952
    v_cvt_pk_bf16_f32 v4, v92, v93
    v_mfma_f32_16x16x32_bf16 v[80:83], a[20:23], v[140:143], v[80:83]
    ds_read_b64_tr_b16 a[52:53], v42 offset:9376
    v_cvt_pk_bf16_f32 v5, v94, v95
    v_mfma_f32_16x16x32_bf16 v[116:119], a[20:23], v[144:147], v[116:119]
    ds_read_b64_tr_b16 a[54:55], v42 offset:13984
    buffer_store_dwordx2 v[4:5], v58, s[52:55], s84 offen sc1
    s_waitcnt lgkmcnt(12)
    v_mfma_f32_16x16x32_bf16 v[84:87], a[24:27], v[140:143], v[84:87]
    ds_read_b64_tr_b16 a[56:57], v42 offset:9408
    v_cvt_pk_bf16_f32 v236, v96, v97
    v_mfma_f32_16x16x32_bf16 v[120:123], a[24:27], v[144:147], v[120:123]
    ds_read_b64_tr_b16 a[58:59], v42 offset:14016
    v_cvt_pk_bf16_f32 v237, v98, v99
    v_mfma_f32_16x16x32_bf16 v[88:91], a[28:31], v[140:143], v[88:91]
    ds_read_b64_tr_b16 a[60:61], v42 offset:9440
    v_cvt_pk_bf16_f32 v238, v100, v101
    v_mfma_f32_16x16x32_bf16 v[124:127], a[28:31], v[144:147], v[124:127]
    ds_read_b64_tr_b16 a[62:63], v42 offset:14048
    v_cvt_pk_bf16_f32 v239, v102, v103
    buffer_store_dwordx4 v[236:239], v57, s[52:55], 0 offen offset:0 sc1
    s_waitcnt lgkmcnt(12)
    v_mfma_f32_16x16x32_bf16 v[76:79], a[32:35], v[148:151], v[76:79]
    ds_read_b64_tr_b16 a[0:1], v42 offset:18560
    v_cvt_pk_bf16_f32 v240, v104, v105
    v_mfma_f32_16x16x32_bf16 v[112:115], a[32:35], v[152:155], v[112:115]
    ds_read_b64_tr_b16 a[2:3], v42 offset:23168
    v_cvt_pk_bf16_f32 v241, v106, v107
    v_mfma_f32_16x16x32_bf16 v[80:83], a[36:39], v[148:151], v[80:83]
    ds_read_b64_tr_b16 a[4:5], v42 offset:18592
    v_cvt_pk_bf16_f32 v242, v108, v109
    v_mfma_f32_16x16x32_bf16 v[116:119], a[36:39], v[152:155], v[116:119]
    ds_read_b64_tr_b16 a[6:7], v42 offset:23200
    v_cvt_pk_bf16_f32 v243, v110, v111
    s_waitcnt lgkmcnt(12)
    v_mfma_f32_16x16x32_bf16 v[84:87], a[40:43], v[148:151], v[84:87]
    ds_read_b64_tr_b16 a[8:9], v42 offset:18624
    buffer_store_dwordx4 v[240:243], v57, s[52:55], 0 offen offset:1024 sc1
    v_mfma_f32_16x16x32_bf16 v[120:123], a[40:43], v[152:155], v[120:123]
    ds_read_b64_tr_b16 a[10:11], v42 offset:23232
    v_cvt_pk_bf16_f32 v6, v128, v129
    v_mfma_f32_16x16x32_bf16 v[88:91], a[44:47], v[148:151], v[88:91]
    ds_read_b64_tr_b16 a[12:13], v42 offset:18656
    v_cvt_pk_bf16_f32 v7, v130, v131
    v_mfma_f32_16x16x32_bf16 v[124:127], a[44:47], v[152:155], v[124:127]
    ds_read_b64_tr_b16 a[14:15], v42 offset:23264
    buffer_store_dwordx2 v[6:7], v59, s[52:55], s84 offen sc1
    s_waitcnt lgkmcnt(12)
    v_mfma_f32_16x16x32_bf16 v[76:79], a[48:51], v[156:159], v[76:79]
    ds_read_b64_tr_b16 a[16:17], v42 offset:27776
    v_mfma_f32_16x16x32_bf16 v[112:115], a[48:51], v[160:163], v[112:115]
    ds_read_b64_tr_b16 a[18:19], v42 offset:32384
    v_mfma_f32_16x16x32_bf16 v[80:83], a[52:55], v[156:159], v[80:83]
    ds_read_b64_tr_b16 a[20:21], v42 offset:27808
    v_mfma_f32_16x16x32_bf16 v[116:119], a[52:55], v[160:163], v[116:119]
    ds_read_b64_tr_b16 a[22:23], v42 offset:32416
    s_waitcnt lgkmcnt(12)
    v_mfma_f32_16x16x32_bf16 v[84:87], a[56:59], v[156:159], v[84:87]
    ds_read_b64_tr_b16 a[24:25], v42 offset:27840
    v_mfma_f32_16x16x32_bf16 v[120:123], a[56:59], v[160:163], v[120:123]
    ds_read_b64_tr_b16 a[26:27], v42 offset:32448
    v_mfma_f32_16x16x32_bf16 v[88:91], a[60:63], v[156:159], v[88:91]
    ds_read_b64_tr_b16 a[28:29], v42 offset:27872
    v_mfma_f32_16x16x32_bf16 v[124:127], a[60:63], v[160:163], v[124:127]
    ds_read_b64_tr_b16 a[30:31], v42 offset:32480
    s_waitcnt lgkmcnt(12)
    v_mfma_f32_16x16x32_bf16 v[76:79], a[0:3], v[196:199], v[76:79]
    ds_read_b64_tr_b16 a[32:33], v42 offset:36992
    v_mfma_f32_16x16x32_bf16 v[112:115], a[0:3], v[200:203], v[112:115]
    ds_read_b64_tr_b16 a[34:35], v42 offset:41600
    v_mfma_f32_16x16x32_bf16 v[80:83], a[4:7], v[196:199], v[80:83]
    ds_read_b64_tr_b16 a[36:37], v42 offset:37024
    v_mfma_f32_16x16x32_bf16 v[116:119], a[4:7], v[200:203], v[116:119]
    ds_read_b64_tr_b16 a[38:39], v42 offset:41632
    s_waitcnt lgkmcnt(12)
    v_mfma_f32_16x16x32_bf16 v[84:87], a[8:11], v[196:199], v[84:87]
    ds_read_b64_tr_b16 a[40:41], v42 offset:37056
    v_mfma_f32_16x16x32_bf16 v[120:123], a[8:11], v[200:203], v[120:123]
    ds_read_b64_tr_b16 a[42:43], v42 offset:41664
    v_mfma_f32_16x16x32_bf16 v[88:91], a[12:15], v[196:199], v[88:91]
    ds_read_b64_tr_b16 a[44:45], v42 offset:37088
    v_mfma_f32_16x16x32_bf16 v[124:127], a[12:15], v[200:203], v[124:127]
    ds_read_b64_tr_b16 a[46:47], v42 offset:41696
    s_waitcnt lgkmcnt(12)
    v_mfma_f32_16x16x32_bf16 v[76:79], a[16:19], v[204:207], v[76:79]
    ds_read_b64_tr_b16 a[48:49], v42 offset:46208
    v_mfma_f32_16x16x32_bf16 v[112:115], a[16:19], v[208:211], v[112:115]
    ds_read_b64_tr_b16 a[50:51], v42 offset:50816
    v_mfma_f32_16x16x32_bf16 v[80:83], a[20:23], v[204:207], v[80:83]
    ds_read_b64_tr_b16 a[52:53], v42 offset:46240
    v_mfma_f32_16x16x32_bf16 v[116:119], a[20:23], v[208:211], v[116:119]
    ds_read_b64_tr_b16 a[54:55], v42 offset:50848
    s_waitcnt lgkmcnt(12)
    v_mfma_f32_16x16x32_bf16 v[84:87], a[24:27], v[204:207], v[84:87]
    ds_read_b64_tr_b16 a[56:57], v42 offset:46272
    v_mfma_f32_16x16x32_bf16 v[120:123], a[24:27], v[208:211], v[120:123]
    ds_read_b64_tr_b16 a[58:59], v42 offset:50880
    v_mfma_f32_16x16x32_bf16 v[88:91], a[28:31], v[204:207], v[88:91]
    ds_read_b64_tr_b16 a[60:61], v42 offset:46304
    v_mfma_f32_16x16x32_bf16 v[124:127], a[28:31], v[208:211], v[124:127]
    ds_read_b64_tr_b16 a[62:63], v42 offset:50912
    s_waitcnt lgkmcnt(12)
    v_mfma_f32_16x16x32_bf16 v[76:79], a[32:35], v[212:215], v[76:79]
    ds_read_b64_tr_b16 a[0:1], v43 offset:128
    v_mfma_f32_16x16x32_bf16 v[112:115], a[32:35], v[216:219], v[112:115]
    ds_read_b64_tr_b16 a[2:3], v43 offset:4736
    v_mfma_f32_16x16x32_bf16 v[80:83], a[36:39], v[212:215], v[80:83]
    ds_read_b64_tr_b16 a[4:5], v43 offset:160
    v_mfma_f32_16x16x32_bf16 v[116:119], a[36:39], v[216:219], v[116:119]
    ds_read_b64_tr_b16 a[6:7], v43 offset:4768
    s_waitcnt lgkmcnt(12)
    v_mfma_f32_16x16x32_bf16 v[84:87], a[40:43], v[212:215], v[84:87]
    ds_read_b64_tr_b16 a[8:9], v43 offset:192
    v_mfma_f32_16x16x32_bf16 v[120:123], a[40:43], v[216:219], v[120:123]
    ds_read_b64_tr_b16 a[10:11], v43 offset:4800
    v_mfma_f32_16x16x32_bf16 v[88:91], a[44:47], v[212:215], v[88:91]
    ds_read_b64_tr_b16 a[12:13], v43 offset:224
    v_mfma_f32_16x16x32_bf16 v[124:127], a[44:47], v[216:219], v[124:127]
    ds_read_b64_tr_b16 a[14:15], v43 offset:4832
    s_waitcnt lgkmcnt(12)
    v_mfma_f32_16x16x32_bf16 v[76:79], a[48:51], v[220:223], v[76:79]
    ds_read_b64_tr_b16 a[16:17], v43 offset:9344
    v_mfma_f32_16x16x32_bf16 v[112:115], a[48:51], v[224:227], v[112:115]
    ds_read_b64_tr_b16 a[18:19], v43 offset:13952
    v_mfma_f32_16x16x32_bf16 v[80:83], a[52:55], v[220:223], v[80:83]
    ds_read_b64_tr_b16 a[20:21], v43 offset:9376
    v_mfma_f32_16x16x32_bf16 v[116:119], a[52:55], v[224:227], v[116:119]
    ds_read_b64_tr_b16 a[22:23], v43 offset:13984
    s_waitcnt lgkmcnt(12)
    v_mfma_f32_16x16x32_bf16 v[84:87], a[56:59], v[220:223], v[84:87]
    ds_read_b64_tr_b16 a[24:25], v43 offset:9408
    v_mfma_f32_16x16x32_bf16 v[120:123], a[56:59], v[224:227], v[120:123]
    ds_read_b64_tr_b16 a[26:27], v43 offset:14016
    v_mfma_f32_16x16x32_bf16 v[88:91], a[60:63], v[220:223], v[88:91]
    ds_read_b64_tr_b16 a[28:29], v43 offset:9440
    v_mfma_f32_16x16x32_bf16 v[124:127], a[60:63], v[224:227], v[124:127]
    ds_read_b64_tr_b16 a[30:31], v43 offset:14048
    s_waitcnt lgkmcnt(12)
    v_mfma_f32_16x16x32_bf16 v[76:79], a[0:3], v[164:167], v[76:79]
    ds_read_b64_tr_b16 a[32:33], v43 offset:18560
    v_mfma_f32_16x16x32_bf16 v[112:115], a[0:3], v[168:171], v[112:115]
    ds_read_b64_tr_b16 a[34:35], v43 offset:23168
    v_mfma_f32_16x16x32_bf16 v[80:83], a[4:7], v[164:167], v[80:83]
    ds_read_b64_tr_b16 a[36:37], v43 offset:18592
    v_mfma_f32_16x16x32_bf16 v[116:119], a[4:7], v[168:171], v[116:119]
    ds_read_b64_tr_b16 a[38:39], v43 offset:23200
    s_waitcnt lgkmcnt(12)
    v_mfma_f32_16x16x32_bf16 v[84:87], a[8:11], v[164:167], v[84:87]
    ds_read_b64_tr_b16 a[40:41], v43 offset:18624
    v_mfma_f32_16x16x32_bf16 v[120:123], a[8:11], v[168:171], v[120:123]
    ds_read_b64_tr_b16 a[42:43], v43 offset:23232
    v_mfma_f32_16x16x32_bf16 v[88:91], a[12:15], v[164:167], v[88:91]
    ds_read_b64_tr_b16 a[44:45], v43 offset:18656
    v_mfma_f32_16x16x32_bf16 v[124:127], a[12:15], v[168:171], v[124:127]
    ds_read_b64_tr_b16 a[46:47], v43 offset:23264
    s_waitcnt lgkmcnt(12)
    v_mfma_f32_16x16x32_bf16 v[76:79], a[16:19], v[172:175], v[76:79]
    ds_read_b64_tr_b16 a[48:49], v43 offset:27776
    s_waitcnt vmcnt(0)
    v_mov_b32 v56, s29
    s_mov_b64 exec, 3
    buffer_store_dword v56, v48, s[52:55], 0 offen sc1
    s_mov_b64 exec, -1
    v_mfma_f32_16x16x32_bf16 v[112:115], a[16:19], v[176:179], v[112:115]
    ds_read_b64_tr_b16 a[50:51], v43 offset:32384
    v_mfma_f32_16x16x32_bf16 v[80:83], a[20:23], v[172:175], v[80:83]
    ds_read_b64_tr_b16 a[52:53], v43 offset:27808
    v_mfma_f32_16x16x32_bf16 v[116:119], a[20:23], v[176:179], v[116:119]
    ds_read_b64_tr_b16 a[54:55], v43 offset:32416
    s_waitcnt lgkmcnt(12)
    v_mfma_f32_16x16x32_bf16 v[84:87], a[24:27], v[172:175], v[84:87]
    ds_read_b64_tr_b16 a[56:57], v43 offset:27840
    v_mfma_f32_16x16x32_bf16 v[120:123], a[24:27], v[176:179], v[120:123]
    ds_read_b64_tr_b16 a[58:59], v43 offset:32448
    v_mfma_f32_16x16x32_bf16 v[88:91], a[28:31], v[172:175], v[88:91]
    ds_read_b64_tr_b16 a[60:61], v43 offset:27872
    v_mfma_f32_16x16x32_bf16 v[124:127], a[28:31], v[176:179], v[124:127]
    ds_read_b64_tr_b16 a[62:63], v43 offset:32480
    s_waitcnt lgkmcnt(12)
    v_mfma_f32_16x16x32_bf16 v[76:79], a[32:35], v[180:183], v[76:79]
    v_mfma_f32_16x16x32_bf16 v[112:115], a[32:35], v[184:187], v[112:115]
    v_mfma_f32_16x16x32_bf16 v[80:83], a[36:39], v[180:183], v[80:83]
    v_mfma_f32_16x16x32_bf16 v[116:119], a[36:39], v[184:187], v[116:119]
    s_waitcnt lgkmcnt(8)
    v_mfma_f32_16x16x32_bf16 v[84:87], a[40:43], v[180:183], v[84:87]
    v_mfma_f32_16x16x32_bf16 v[120:123], a[40:43], v[184:187], v[120:123]
    v_mfma_f32_16x16x32_bf16 v[88:91], a[44:47], v[180:183], v[88:91]
    v_mfma_f32_16x16x32_bf16 v[124:127], a[44:47], v[184:187], v[124:127]
    s_waitcnt lgkmcnt(4)
    v_mfma_f32_16x16x32_bf16 v[76:79], a[48:51], v[188:191], v[76:79]
    v_mfma_f32_16x16x32_bf16 v[112:115], a[48:51], v[192:195], v[112:115]
    v_mfma_f32_16x16x32_bf16 v[80:83], a[52:55], v[188:191], v[80:83]
    v_mfma_f32_16x16x32_bf16 v[116:119], a[52:55], v[192:195], v[116:119]
    s_waitcnt lgkmcnt(0)
    v_mfma_f32_16x16x32_bf16 v[84:87], a[56:59], v[188:191], v[84:87]
    v_mfma_f32_16x16x32_bf16 v[120:123], a[56:59], v[192:195], v[120:123]
    v_mfma_f32_16x16x32_bf16 v[88:91], a[60:63], v[188:191], v[88:91]
    v_mfma_f32_16x16x32_bf16 v[124:127], a[60:63], v[192:195], v[124:127]
    s_nop 7
    v_cvt_pk_bf16_f32 v164, v76, v77
    v_cvt_pk_bf16_f32 v165, v78, v79
    v_cvt_pk_bf16_f32 v166, v80, v81
    v_cvt_pk_bf16_f32 v167, v82, v83
    v_cvt_pk_bf16_f32 v168, v84, v85
    v_cvt_pk_bf16_f32 v169, v86, v87
    v_cvt_pk_bf16_f32 v170, v88, v89
    v_cvt_pk_bf16_f32 v171, v90, v91
    v_cvt_pk_bf16_f32 v172, v112, v113
    v_cvt_pk_bf16_f32 v173, v114, v115
    v_cvt_pk_bf16_f32 v174, v116, v117
    v_cvt_pk_bf16_f32 v175, v118, v119
    v_cvt_pk_bf16_f32 v176, v120, v121
    v_cvt_pk_bf16_f32 v177, v122, v123
    v_cvt_pk_bf16_f32 v178, v124, v125
    v_cvt_pk_bf16_f32 v179, v126, v127
    buffer_store_dwordx4 v[164:167], v45, s[52:55], 0 offen offset:2048 sc1
    buffer_store_dwordx4 v[168:171], v45, s[52:55], 0 offen offset:3072 sc1
    buffer_store_dwordx4 v[172:175], v57, s[52:55], 0 offen offset:2048 sc1
    buffer_store_dwordx4 v[176:179], v57, s[52:55], 0 offen offset:3072 sc1
    s_waitcnt vmcnt(0)
    v_mov_b32 v56, s29
    s_mov_b64 exec, 3
    buffer_store_dword v56, v48, s[52:55], s91 offen sc1
    s_mov_b64 exec, -1
    s_mov_b32 s32, 0
    s_mov_b32 s33, 4608
    s_mov_b32 s34, 9216
    s_mov_b32 s35, 13824
    s_mov_b32 s36, 18432
    s_mov_b32 s37, 23040
    s_mov_b32 s38, 27648
    s_mov_b32 s39, 32256
    v_lshlrev_b32 v55, 3, v0
    v_sub_u32 v55, v46, v55
    v_add_u32 v55, 4096, v55
    s_cmp_ge_u32 s68, 2
    s_cselect_b32 s78, s91, 0
    s_waitcnt vmcnt(0)
    s_mov_b32 s90, 0
L_pv_7:
    buffer_load_dword v50, v3, s[52:55], s78 offen sc1
    s_add_u32 s90, s90, 1
    s_waitcnt vmcnt(0)
    v_cmp_ne_u32 vcc, s29, v50
    s_cmp_lt_u32 s90, 524288
    s_nop 3
    s_cbranch_vccz L_pok_8
    s_cbranch_scc1 L_pv_7
L_pok_8:
    s_cmp_eq_u32 s68, 0
    s_cbranch_scc1 L_w3_9
    buffer_load_dwordx4 v[60:63], v46, s[52:55], s32 offen sc1
    buffer_load_dwordx4 v[64:67], v46, s[52:55], s33 offen sc1
    buffer_load_dwordx4 v[68:71], v46, s[52:55], s34 offen sc1
    buffer_load_dwordx4 v[72:75], v46, s[52:55], s35 offen sc1
    buffer_load_dwordx4 v[76:79], v46, s[52:55], s36 offen sc1
    buffer_load_dwordx4 v[80:83], v46, s[52:55], s37 offen sc1
    buffer_load_dwordx4 v[84:87], v46, s[52:55], s38 offen sc1
    buffer_load_dwordx4 v[88:91], v46, s[52:55], s39 offen sc1
    s_waitcnt vmcnt(7)
    v_lshlrev_b32 v108, 16, v60
    v_and_b32 v109, 0xffff0000, v60
    v_lshlrev_b32 v110, 16, v61
    v_and_b32 v111, 0xffff0000, v61
    v_lshlrev_b32 v112, 16, v62
    v_and_b32 v113, 0xffff0000, v62
    v_lshlrev_b32 v114, 16, v63
    v_and_b32 v115, 0xffff0000, v63
    s_waitcnt vmcnt(6)
    v_lshlrev_b32 v120, 16, v64
    v_and_b32 v121, 0xffff0000, v64
    v_pk_add_f32 v[108:109], v[108:109], v[120:121]
    v_lshlrev_b32 v122, 16, v65
    v_and_b32 v123, 0xffff0000, v65
    v_pk_add_f32 v[110:111], v[110:111], v[122:123]
    v_lshlrev_b32 v120, 16, v66
    v_and_b32 v121, 0xffff0000, v66
    v_pk_add_f32 v[112:113], v[112:113], v[120:121]
    v_lshlrev_b32 v122, 16, v67
    v_and_b32 v123, 0xffff0000, v67
    v_pk_add_f32 v[114:115], v[114:115], v[122:123]
    s_waitcnt vmcnt(5)
    v_lshlrev_b32 v120, 16, v68
    v_and_b32 v121, 0xffff0000, v68
    v_pk_add_f32 v[108:109], v[108:109], v[120:121]
    v_lshlrev_b32 v122, 16, v69
    v_and_b32 v123, 0xffff0000, v69
    v_pk_add_f32 v[110:111], v[110:111], v[122:123]
    v_lshlrev_b32 v120, 16, v70
    v_and_b32 v121, 0xffff0000, v70
    v_pk_add_f32 v[112:113], v[112:113], v[120:121]
    v_lshlrev_b32 v122, 16, v71
    v_and_b32 v123, 0xffff0000, v71
    v_pk_add_f32 v[114:115], v[114:115], v[122:123]
    s_waitcnt vmcnt(4)
    v_lshlrev_b32 v120, 16, v72
    v_and_b32 v121, 0xffff0000, v72
    v_pk_add_f32 v[108:109], v[108:109], v[120:121]
    v_lshlrev_b32 v122, 16, v73
    v_and_b32 v123, 0xffff0000, v73
    v_pk_add_f32 v[110:111], v[110:111], v[122:123]
    v_lshlrev_b32 v120, 16, v74
    v_and_b32 v121, 0xffff0000, v74
    v_pk_add_f32 v[112:113], v[112:113], v[120:121]
    v_lshlrev_b32 v122, 16, v75
    v_and_b32 v123, 0xffff0000, v75
    v_pk_add_f32 v[114:115], v[114:115], v[122:123]
    s_waitcnt vmcnt(3)
    v_lshlrev_b32 v120, 16, v76
    v_and_b32 v121, 0xffff0000, v76
    v_pk_add_f32 v[108:109], v[108:109], v[120:121]
    v_lshlrev_b32 v122, 16, v77
    v_and_b32 v123, 0xffff0000, v77
    v_pk_add_f32 v[110:111], v[110:111], v[122:123]
    v_lshlrev_b32 v120, 16, v78
    v_and_b32 v121, 0xffff0000, v78
    v_pk_add_f32 v[112:113], v[112:113], v[120:121]
    v_lshlrev_b32 v122, 16, v79
    v_and_b32 v123, 0xffff0000, v79
    v_pk_add_f32 v[114:115], v[114:115], v[122:123]
    s_waitcnt vmcnt(2)
    v_lshlrev_b32 v120, 16, v80
    v_and_b32 v121, 0xffff0000, v80
    v_pk_add_f32 v[108:109], v[108:109], v[120:121]
    v_lshlrev_b32 v122, 16, v81
    v_and_b32 v123, 0xffff0000, v81
    v_pk_add_f32 v[110:111], v[110:111], v[122:123]
    v_lshlrev_b32 v120, 16, v82
    v_and_b32 v121, 0xffff0000, v82
    v_pk_add_f32 v[112:113], v[112:113], v[120:121]
    v_lshlrev_b32 v122, 16, v83
    v_and_b32 v123, 0xffff0000, v83
    v_pk_add_f32 v[114:115], v[114:115], v[122:123]
    s_waitcnt vmcnt(1)
    v_lshlrev_b32 v120, 16, v84
    v_and_b32 v121, 0xffff0000, v84
    v_pk_add_f32 v[108:109], v[108:109], v[120:121]
    v_lshlrev_b32 v122, 16, v85
    v_and_b32 v123, 0xffff0000, v85
    v_pk_add_f32 v[110:111], v[110:111], v[122:123]
    v_lshlrev_b32 v120, 16, v86
    v_and_b32 v121, 0xffff0000, v86
    v_pk_add_f32 v[112:113], v[112:113], v[120:121]
    v_lshlrev_b32 v122, 16, v87
    v_and_b32 v123, 0xffff0000, v87
    v_pk_add_f32 v[114:115], v[114:115], v[122:123]
    s_waitcnt vmcnt(0)
    v_lshlrev_b32 v120, 16, v88
    v_and_b32 v121, 0xffff0000, v88
    v_pk_add_f32 v[108:109], v[108:109], v[120:121]
    v_lshlrev_b32 v122, 16, v89
    v_and_b32 v123, 0xffff0000, v89
    v_pk_add_f32 v[110:111], v[110:111], v[122:123]
    v_lshlrev_b32 v120, 16, v90
    v_and_b32 v121, 0xffff0000, v90
    v_pk_add_f32 v[112:113], v[112:113], v[120:121]
    v_lshlrev_b32 v122, 16, v91
    v_and_b32 v123, 0xffff0000, v91
    v_pk_add_f32 v[114:115], v[114:115], v[122:123]
    v_cvt_pk_bf16_f32 v108, v108, v109
    v_cvt_pk_bf16_f32 v109, v110, v111
    v_cvt_pk_bf16_f32 v110, v112, v113
    v_cvt_pk_bf16_f32 v111, v114, v115
    buffer_store_dwordx2 v[108:109], v47, s[56:59], 0 offen offset:0
    buffer_store_dwordx2 v[110:111], v47, s[56:59], 0 offen offset:32
    s_branch L_fin_10
L_w3_9:
    buffer_load_dwordx4 v[60:63], v46, s[52:55], s32 offen sc1
    buffer_load_dwordx2 v[92:93], v55, s[52:55], s32 offen sc1
    buffer_load_dwordx4 v[64:67], v46, s[52:55], s33 offen sc1
    buffer_load_dwordx2 v[94:95], v55, s[52:55], s33 offen sc1
    buffer_load_dwordx4 v[68:71], v46, s[52:55], s34 offen sc1
    buffer_load_dwordx2 v[96:97], v55, s[52:55], s34 offen sc1
    buffer_load_dwordx4 v[72:75], v46, s[52:55], s35 offen sc1
    buffer_load_dwordx2 v[98:99], v55, s[52:55], s35 offen sc1
    buffer_load_dwordx4 v[76:79], v46, s[52:55], s36 offen sc1
    buffer_load_dwordx2 v[100:101], v55, s[52:55], s36 offen sc1
    buffer_load_dwordx4 v[80:83], v46, s[52:55], s37 offen sc1
    buffer_load_dwordx2 v[102:103], v55, s[52:55], s37 offen sc1
    buffer_load_dwordx4 v[84:87], v46, s[52:55], s38 offen sc1
    buffer_load_dwordx2 v[104:105], v55, s[52:55], s38 offen sc1
    buffer_load_dwordx4 v[88:91], v46, s[52:55], s39 offen sc1
    buffer_load_dwordx2 v[106:107], v55, s[52:55], s39 offen sc1
    s_waitcnt vmcnt(14)
    v_lshlrev_b32 v108, 16, v60
    v_and_b32 v109, 0xffff0000, v60
    v_lshlrev_b32 v110, 16, v61
    v_and_b32 v111, 0xffff0000, v61
    v_lshlrev_b32 v112, 16, v62
    v_and_b32 v113, 0xffff0000, v62
    v_lshlrev_b32 v114, 16, v63
    v_and_b32 v115, 0xffff0000, v63
    v_lshlrev_b32 v116, 16, v92
    v_and_b32 v117, 0xffff0000, v92
    v_lshlrev_b32 v118, 16, v93
    v_and_b32 v119, 0xffff0000, v93
    s_waitcnt vmcnt(12)
    v_lshlrev_b32 v120, 16, v64
    v_and_b32 v121, 0xffff0000, v64
    v_pk_add_f32 v[108:109], v[108:109], v[120:121]
    v_lshlrev_b32 v122, 16, v65
    v_and_b32 v123, 0xffff0000, v65
    v_pk_add_f32 v[110:111], v[110:111], v[122:123]
    v_lshlrev_b32 v120, 16, v66
    v_and_b32 v121, 0xffff0000, v66
    v_pk_add_f32 v[112:113], v[112:113], v[120:121]
    v_lshlrev_b32 v122, 16, v67
    v_and_b32 v123, 0xffff0000, v67
    v_pk_add_f32 v[114:115], v[114:115], v[122:123]
    v_lshlrev_b32 v120, 16, v94
    v_and_b32 v121, 0xffff0000, v94
    v_pk_add_f32 v[116:117], v[116:117], v[120:121]
    v_lshlrev_b32 v122, 16, v95
    v_and_b32 v123, 0xffff0000, v95
    v_pk_add_f32 v[118:119], v[118:119], v[122:123]
    s_waitcnt vmcnt(10)
    v_lshlrev_b32 v120, 16, v68
    v_and_b32 v121, 0xffff0000, v68
    v_pk_add_f32 v[108:109], v[108:109], v[120:121]
    v_lshlrev_b32 v122, 16, v69
    v_and_b32 v123, 0xffff0000, v69
    v_pk_add_f32 v[110:111], v[110:111], v[122:123]
    v_lshlrev_b32 v120, 16, v70
    v_and_b32 v121, 0xffff0000, v70
    v_pk_add_f32 v[112:113], v[112:113], v[120:121]
    v_lshlrev_b32 v122, 16, v71
    v_and_b32 v123, 0xffff0000, v71
    v_pk_add_f32 v[114:115], v[114:115], v[122:123]
    v_lshlrev_b32 v120, 16, v96
    v_and_b32 v121, 0xffff0000, v96
    v_pk_add_f32 v[116:117], v[116:117], v[120:121]
    v_lshlrev_b32 v122, 16, v97
    v_and_b32 v123, 0xffff0000, v97
    v_pk_add_f32 v[118:119], v[118:119], v[122:123]
    s_waitcnt vmcnt(8)
    v_lshlrev_b32 v120, 16, v72
    v_and_b32 v121, 0xffff0000, v72
    v_pk_add_f32 v[108:109], v[108:109], v[120:121]
    v_lshlrev_b32 v122, 16, v73
    v_and_b32 v123, 0xffff0000, v73
    v_pk_add_f32 v[110:111], v[110:111], v[122:123]
    v_lshlrev_b32 v120, 16, v74
    v_and_b32 v121, 0xffff0000, v74
    v_pk_add_f32 v[112:113], v[112:113], v[120:121]
    v_lshlrev_b32 v122, 16, v75
    v_and_b32 v123, 0xffff0000, v75
    v_pk_add_f32 v[114:115], v[114:115], v[122:123]
    v_lshlrev_b32 v120, 16, v98
    v_and_b32 v121, 0xffff0000, v98
    v_pk_add_f32 v[116:117], v[116:117], v[120:121]
    v_lshlrev_b32 v122, 16, v99
    v_and_b32 v123, 0xffff0000, v99
    v_pk_add_f32 v[118:119], v[118:119], v[122:123]
    s_waitcnt vmcnt(6)
    v_lshlrev_b32 v120, 16, v76
    v_and_b32 v121, 0xffff0000, v76
    v_pk_add_f32 v[108:109], v[108:109], v[120:121]
    v_lshlrev_b32 v122, 16, v77
    v_and_b32 v123, 0xffff0000, v77
    v_pk_add_f32 v[110:111], v[110:111], v[122:123]
    v_lshlrev_b32 v120, 16, v78
    v_and_b32 v121, 0xffff0000, v78
    v_pk_add_f32 v[112:113], v[112:113], v[120:121]
    v_lshlrev_b32 v122, 16, v79
    v_and_b32 v123, 0xffff0000, v79
    v_pk_add_f32 v[114:115], v[114:115], v[122:123]
    v_lshlrev_b32 v120, 16, v100
    v_and_b32 v121, 0xffff0000, v100
    v_pk_add_f32 v[116:117], v[116:117], v[120:121]
    v_lshlrev_b32 v122, 16, v101
    v_and_b32 v123, 0xffff0000, v101
    v_pk_add_f32 v[118:119], v[118:119], v[122:123]
    s_waitcnt vmcnt(4)
    v_lshlrev_b32 v120, 16, v80
    v_and_b32 v121, 0xffff0000, v80
    v_pk_add_f32 v[108:109], v[108:109], v[120:121]
    v_lshlrev_b32 v122, 16, v81
    v_and_b32 v123, 0xffff0000, v81
    v_pk_add_f32 v[110:111], v[110:111], v[122:123]
    v_lshlrev_b32 v120, 16, v82
    v_and_b32 v121, 0xffff0000, v82
    v_pk_add_f32 v[112:113], v[112:113], v[120:121]
    v_lshlrev_b32 v122, 16, v83
    v_and_b32 v123, 0xffff0000, v83
    v_pk_add_f32 v[114:115], v[114:115], v[122:123]
    v_lshlrev_b32 v120, 16, v102
    v_and_b32 v121, 0xffff0000, v102
    v_pk_add_f32 v[116:117], v[116:117], v[120:121]
    v_lshlrev_b32 v122, 16, v103
    v_and_b32 v123, 0xffff0000, v103
    v_pk_add_f32 v[118:119], v[118:119], v[122:123]
    s_waitcnt vmcnt(2)
    v_lshlrev_b32 v120, 16, v84
    v_and_b32 v121, 0xffff0000, v84
    v_pk_add_f32 v[108:109], v[108:109], v[120:121]
    v_lshlrev_b32 v122, 16, v85
    v_and_b32 v123, 0xffff0000, v85
    v_pk_add_f32 v[110:111], v[110:111], v[122:123]
    v_lshlrev_b32 v120, 16, v86
    v_and_b32 v121, 0xffff0000, v86
    v_pk_add_f32 v[112:113], v[112:113], v[120:121]
    v_lshlrev_b32 v122, 16, v87
    v_and_b32 v123, 0xffff0000, v87
    v_pk_add_f32 v[114:115], v[114:115], v[122:123]
    v_lshlrev_b32 v120, 16, v104
    v_and_b32 v121, 0xffff0000, v104
    v_pk_add_f32 v[116:117], v[116:117], v[120:121]
    v_lshlrev_b32 v122, 16, v105
    v_and_b32 v123, 0xffff0000, v105
    v_pk_add_f32 v[118:119], v[118:119], v[122:123]
    s_waitcnt vmcnt(0)
    v_lshlrev_b32 v120, 16, v88
    v_and_b32 v121, 0xffff0000, v88
    v_pk_add_f32 v[108:109], v[108:109], v[120:121]
    v_lshlrev_b32 v122, 16, v89
    v_and_b32 v123, 0xffff0000, v89
    v_pk_add_f32 v[110:111], v[110:111], v[122:123]
    v_lshlrev_b32 v120, 16, v90
    v_and_b32 v121, 0xffff0000, v90
    v_pk_add_f32 v[112:113], v[112:113], v[120:121]
    v_lshlrev_b32 v122, 16, v91
    v_and_b32 v123, 0xffff0000, v91
    v_pk_add_f32 v[114:115], v[114:115], v[122:123]
    v_lshlrev_b32 v120, 16, v106
    v_and_b32 v121, 0xffff0000, v106
    v_pk_add_f32 v[116:117], v[116:117], v[120:121]
    v_lshlrev_b32 v122, 16, v107
    v_and_b32 v123, 0xffff0000, v107
    v_pk_add_f32 v[118:119], v[118:119], v[122:123]
    v_cvt_pk_bf16_f32 v108, v108, v109
    v_cvt_pk_bf16_f32 v109, v110, v111
    v_cvt_pk_bf16_f32 v110, v112, v113
    v_cvt_pk_bf16_f32 v111, v114, v115
    v_cvt_pk_bf16_f32 v112, v116, v117
    v_cvt_pk_bf16_f32 v113, v118, v119
    buffer_store_dwordx2 v[108:109], v47, s[56:59], 0 offen offset:0
    buffer_store_dwordx2 v[110:111], v47, s[56:59], 0 offen offset:32
    buffer_store_dwordx2 v[112:113], v47, s[56:59], 0 offen offset:256
L_fin_10:
L_end:
    s_endpgm
.section .rodata,"a"
.p2align 6
.amdhsa_kernel concat_heads__gqa_block_cached__gqa_block_cached__near_ridge_kernel
  .amdhsa_next_free_vgpr 424
  .amdhsa_next_free_sgpr 102
  .amdhsa_accum_offset 256
  .amdhsa_group_segment_fixed_size 0
  .amdhsa_kernarg_size 104
  .amdhsa_user_sgpr_count 2
  .amdhsa_user_sgpr_kernarg_segment_ptr 1
  .amdhsa_system_sgpr_workgroup_id_x 1
  .amdhsa_float_denorm_mode_32 3
.end_amdhsa_kernel
```
